```python
import torch

def _softmax(x, axis=-1):
    return torch.softmax(x, dim=axis)

def _gelu(x):
    return torch.nn.functional.gelu(x, approximate='tanh')

def _silu(x):
    return torch.nn.functional.silu(x)

def _sigmoid(x):
    return torch.sigmoid(x)

def _layernorm(x, axis=-1, eps=1e-05):
    m = x.mean(dim=axis, keepdim=True)
    v = x.var(dim=axis, keepdim=True, unbiased=False)
    return (x - m) / torch.sqrt(v + eps)

def _scatter_add(tgt, idx, src, axis=0):
    return tgt.clone().index_add_(axis, idx, src)

def _segment_sum(src, seg, n):
    out = torch.zeros((n,) + src.shape[1:], dtype=src.dtype)
    return out.index_add_(0, seg, src)

def _pad(x, pw):
    flat = tuple((v for pair in reversed(pw) for v in pair))
    return torch.nn.functional.pad(x, flat)
kernel_name = 'standalone__varlen_attn_packed__ragged'

def setup_inputs():

    _w = lambda a: (lambda t: t.to(torch.bfloat16) if t.is_floating_point() else t)(torch.as_tensor(a))
    cu = torch.tensor([0, 238, 376, 669, 835, 1320, 1545, 1865, 2058], dtype=torch.int64)
    T, H, D = (int(cu[-1]), 16, 192)
    return {'q': _w((lambda *s: torch.randn(*s, dtype=torch.bfloat16) * 0.8)(T, H, D)), 'k': _w((lambda *s: torch.randn(*s, dtype=torch.bfloat16) * 0.8)(T, H, D)), 'v': _w((lambda *s: torch.randn(*s, dtype=torch.bfloat16) * 0.05)(T, H, D)), 'cu': _w(cu)}

def reference(q, k, v, cu):
    T, H, D = q.shape
    out = torch.zeros_like(q)
    scale = D ** (-0.5)
    outs = []
    for i in range(len(cu) - 1):
        s, e = (int(cu[i]), int(cu[i + 1]))
        qi, ki, vi = (q[s:e].clone(), k[s:e].clone(), v[s:e].clone())
        p = _softmax(torch.einsum('qhd,khd->hqk', qi, ki) * scale, axis=-1)
        outs.append(torch.einsum('hqk,khd->qhd', p, vi))
    return torch.concatenate(outs, axis=0)
```

```asm
; @launch grid=(256,1,1) block=(512,1,1) lds=163840
.amdgcn_target "amdgcn-amd-amdhsa--gfx950"
.text
.globl standalone__varlen_attn_packed__ragged_kernel
.p2align 8
.type standalone__varlen_attn_packed__ragged_kernel,@function
standalone__varlen_attn_packed__ragged_kernel:
    s_cmp_ge_u32 s2, 256
    s_cbranch_scc1 L_end
    s_load_dwordx8 s[4:11], s[0:1], 0
    s_load_dwordx2 s[12:13], s[0:1], 32
    s_getpc_b64 s[92:93]
L_pc:
    v_lshrrev_b32 v1, 6, v0
    v_lshlrev_b32 v2, 7, v0
    v_readfirstlane_b32 s28, v1
    v_min_u32 v2, L_table-L_pc-4, v2
    global_load_dword v19, v2, s[92:93]
    s_and_b32 s29, s2, 0xf8
    s_add_u32 s92, s92, L_table-L_pc
    s_addc_u32 s93, s93, 0
    s_add_u32 s29, s29, s28
    s_lshl_b32 s29, s29, 6
    s_cmp_ge_u32 s2, 112
    s_cbranch_scc1 L_late_back
    s_load_dwordx16 s[32:47], s[92:93], s29
L_late_back:
    v_and_b32 v0, 63, v0
    s_and_b32 s15, s2, 7
    s_mul_i32 s15, s15, 768
    v_lshrrev_b32 v1, 3, v0
    v_and_b32 v2, 7, v0
    v_bfe_u32 v3, v0, 4, 2
    v_bfe_u32 v4, v0, 4, 1
    v_mul_u32_u24 v1, 6144, v1
    v_xor_b32 v3, v2, v3
    v_lshlrev_b32 v4, 2, v4
    v_xor_b32 v4, v2, v4
    v_lshl_add_u32 v5, v3, 4, v1
    v_lshl_add_u32 v7, v4, 4, v1
    v_xor_b32 v6, 64, v5
    s_mov_b32 s19, 0x00020000
    s_mov_b32 s23, 0x00020000
    s_mov_b32 s27, 0x00020000
    s_mov_b32 s56, 0x3dd53b95
    s_mov_b32 s57, 0x53800000
    s_mov_b32 s61, 0
    s_lshr_b32 s30, s2, 3
    s_mul_i32 s31, s28, 18
    s_add_u32 s30, s30, s31
    s_sub_u32 s30, s30, 14
    s_mov_b32 s62, 0xd0c
    s_cmp_ge_u32 s30, 61
    s_cselect_b32 s62, 0x56d, s62
    s_cmp_ge_u32 s30, 69
    s_cselect_b32 s62, 0x46e, s62
    s_and_b32 s60, s62, 3
    s_ashr_i32 s62, s62, 2
    s_lshl3_add_u32 s62, s30, s62
    s_mul_i32 s62, s62, 6144
    s_add_u32 s62, s62, s15
    v_min_u32 v2, 5, v2
    v_lshl_add_u32 v8, v2, 7, v1
    s_mov_b32 s22, 12644352
    s_waitcnt lgkmcnt(0)
    s_cmp_lt_u32 s2, 112
    s_cbranch_scc1 L_early
    s_cmp_eq_u32 s60, 1
    s_cselect_b32 s20, s6, s4
    s_cselect_b32 s21, s7, s5
    s_cmp_eq_u32 s60, 2
    s_cselect_b32 s20, s8, s20
    s_cselect_b32 s21, s9, s21
    s_cmp_ge_u32 s30, 73
    s_cbranch_scc1 L_late2
    buffer_load_dword v19, v8, s[20:23], s62 offen
L_late2:
    s_load_dwordx16 s[32:47], s[92:93], s29
    s_lshr_b32 s29, s29, 1
    s_add_u32 s29, s29, L_table2-L_table
    s_load_dwordx8 s[48:55], s[92:93], s29
    s_waitcnt lgkmcnt(0)
L_early:
    s_mov_b32 s16, s4
    s_mov_b32 s17, s5
    s_mov_b32 s18, s33
    s_add_u32 s34, s34, s15
    s_lshr_b32 s14, s32, 28
    s_cbranch_scc1 L_pref
L_pref_done:
    s_bitcmp1_b32 s32, 1
    s_cbranch_scc0 L_loader
    s_add_u32 s29, s34, 0
    s_add_u32 m0, s35, 0
    s_nop 0
    buffer_load_dwordx4 v5, s[16:19], s29 offen offset:0  lds
    s_add_u32 m0, s35, 3968
    s_nop 0
    buffer_load_dwordx4 v5, s[16:19], s29 offen offset:128  lds
    s_add_u32 m0, s35, 7936
    s_nop 0
    buffer_load_dwordx4 v5, s[16:19], s29 offen offset:256  lds
    s_add_u32 s29, s34, 49152
    s_add_u32 m0, s35, 1024
    s_nop 0
    buffer_load_dwordx4 v6, s[16:19], s29 offen offset:0  lds
    s_add_u32 m0, s35, 4992
    s_nop 0
    buffer_load_dwordx4 v6, s[16:19], s29 offen offset:128  lds
    s_add_u32 m0, s35, 8960
    s_nop 0
    buffer_load_dwordx4 v6, s[16:19], s29 offen offset:256  lds
    s_add_u32 s29, s34, 98304
    s_add_u32 m0, s35, 2048
    s_nop 0
    buffer_load_dwordx4 v5, s[16:19], s29 offen offset:0  lds
    s_add_u32 m0, s35, 6016
    s_nop 0
    buffer_load_dwordx4 v5, s[16:19], s29 offen offset:128  lds
    s_add_u32 m0, s35, 9984
    s_nop 0
    buffer_load_dwordx4 v5, s[16:19], s29 offen offset:256  lds
    s_add_u32 s29, s34, 147456
    s_add_u32 m0, s35, 3072
    s_nop 0
    buffer_load_dwordx4 v6, s[16:19], s29 offen offset:0  lds
    s_add_u32 m0, s35, 7040
    s_nop 0
    buffer_load_dwordx4 v6, s[16:19], s29 offen offset:128  lds
    s_add_u32 m0, s35, 11008
    s_nop 0
    buffer_load_dwordx4 v6, s[16:19], s29 offen offset:256  lds
L_noq:
    s_sub_u32 s49, s40, 1
    s_mov_b32 s22, s33
    v_and_b32 v1, 31, v0
    v_lshrrev_b32 v2, 5, v0
    v_lshlrev_b32 v8, 2, v2
    v_bfe_u32 v3, v1, 1, 3
    v_xor_b32 v3, v3, v2
    v_lshlrev_b32 v3, 4, v3
    v_lshl_add_u32 v9, v1, 7, v3
    v_bfe_u32 v4, v0, 2, 2
    v_and_b32 v5, 3, v0
    v_bfe_u32 v6, v0, 4, 1
    v_bfe_u32 v7, v0, 3, 1
    v_add_u32 v4, v4, v8
    v_lshlrev_b32 v10, 7, v4
    v_lshl_add_u32 v10, v7, 6, v10
    v_lshl_add_u32 v10, v6, 5, v10
    v_lshl_add_u32 v10, v5, 3, v10
    v_mov_b32 v160, 0
    v_mov_b32 v161, 0
    v_mov_b32 v162, 0
    v_mov_b32 v163, 0
    v_mov_b32 v164, 0
    v_mov_b32 v165, 0
    v_mov_b32 v166, 0
    v_mov_b32 v167, 0
    v_mov_b32 v168, 0
    v_mov_b32 v169, 0
    v_mov_b32 v170, 0
    v_mov_b32 v171, 0
    v_mov_b32 v172, 0
    v_mov_b32 v173, 0
    v_mov_b32 v174, 0
    v_mov_b32 v175, 0
    v_mov_b32 v176, 0
    v_mov_b32 v177, 0
    v_mov_b32 v178, 0
    v_mov_b32 v179, 0
    v_mov_b32 v180, 0
    v_mov_b32 v181, 0
    v_mov_b32 v182, 0
    v_mov_b32 v183, 0
    v_mov_b32 v184, 0
    v_mov_b32 v185, 0
    v_mov_b32 v186, 0
    v_mov_b32 v187, 0
    v_mov_b32 v188, 0
    v_mov_b32 v189, 0
    v_mov_b32 v190, 0
    v_mov_b32 v191, 0
    v_mov_b32 v192, 0
    v_mov_b32 v193, 0
    v_mov_b32 v194, 0
    v_mov_b32 v195, 0
    v_mov_b32 v196, 0
    v_mov_b32 v197, 0
    v_mov_b32 v198, 0
    v_mov_b32 v199, 0
    v_mov_b32 v200, 0
    v_mov_b32 v201, 0
    v_mov_b32 v202, 0
    v_mov_b32 v203, 0
    v_mov_b32 v204, 0
    v_mov_b32 v205, 0
    v_mov_b32 v206, 0
    v_mov_b32 v207, 0
    v_mov_b32 v208, 0
    v_mov_b32 v209, 0
    v_mov_b32 v210, 0
    v_mov_b32 v211, 0
    v_mov_b32 v212, 0
    v_mov_b32 v213, 0
    v_mov_b32 v214, 0
    v_mov_b32 v215, 0
    v_mov_b32 v216, 0
    v_mov_b32 v217, 0
    v_mov_b32 v218, 0
    v_mov_b32 v219, 0
    v_mov_b32 v220, 0
    v_mov_b32 v221, 0
    v_mov_b32 v222, 0
    v_mov_b32 v223, 0
    v_mov_b32 v224, 0
    v_mov_b32 v225, 0
    v_mov_b32 v226, 0
    v_mov_b32 v227, 0
    v_mov_b32 v228, 0
    v_mov_b32 v229, 0
    v_mov_b32 v230, 0
    v_mov_b32 v231, 0
    v_mov_b32 v232, 0
    v_mov_b32 v233, 0
    v_mov_b32 v234, 0
    v_mov_b32 v235, 0
    v_mov_b32 v236, 0
    v_mov_b32 v237, 0
    v_mov_b32 v238, 0
    v_mov_b32 v239, 0
    v_mov_b32 v240, 0
    v_mov_b32 v241, 0
    v_mov_b32 v242, 0
    v_mov_b32 v243, 0
    v_mov_b32 v244, 0
    v_mov_b32 v245, 0
    v_mov_b32 v246, 0
    v_mov_b32 v247, 0
    v_mov_b32 v248, 0
    v_mov_b32 v249, 0
    v_mov_b32 v250, 0
    v_mov_b32 v251, 0
    v_mov_b32 v252, 0
    v_mov_b32 v253, 0
    v_mov_b32 v254, 0
    v_mov_b32 v255, 0
    v_mov_b32 v20, 0
    v_mov_b32 v22, 0
    s_mov_b32 s26, s33
    s_mov_b32 s24, s12
    s_mov_b32 s25, s13
    s_lshr_b32 s51, s40, 1
    v_add_u32 v11, s35, v9
    v_xor_b32 v12, 32, v11
    v_xor_b32 v13, 64, v11
    v_xor_b32 v14, 96, v11
    s_waitcnt vmcnt(0)
    ds_read_b128 v[112:115], v11 offset:0
    ds_read_b128 v[116:119], v12 offset:0
    ds_read_b128 v[120:123], v13 offset:0
    ds_read_b128 v[124:127], v14 offset:0
    ds_read_b128 v[128:131], v11 offset:4096
    ds_read_b128 v[132:135], v12 offset:4096
    ds_read_b128 v[136:139], v13 offset:4096
    ds_read_b128 v[140:143], v14 offset:4096
    ds_read_b128 v[144:147], v11 offset:8192
    ds_read_b128 v[148:151], v12 offset:8192
    ds_read_b128 v[152:155], v13 offset:8192
    ds_read_b128 v[156:159], v14 offset:8192
    v_add_u32 v11, s42, v9
    v_xor_b32 v12, 32, v11
    v_xor_b32 v13, 64, v11
    v_xor_b32 v14, 96, v11
    s_waitcnt lgkmcnt(0)
    s_barrier
    ds_read_b128 v[24:27], v11 offset:0
    ds_read_b128 v[28:31], v12 offset:0
    ds_read_b128 v[32:35], v13 offset:0
    ds_read_b128 v[36:39], v14 offset:0
    ds_read_b128 v[40:43], v11 offset:4096
    ds_read_b128 v[44:47], v12 offset:4096
    ds_read_b128 v[48:51], v13 offset:4096
    ds_read_b128 v[52:55], v14 offset:4096
    ds_read_b128 v[56:59], v11 offset:8192
    ds_read_b128 v[60:63], v12 offset:8192
    ds_read_b128 v[64:67], v13 offset:8192
    ds_read_b128 v[68:71], v14 offset:8192
    s_bitcmp1_b32 s32, 4
    s_cbranch_scc1 L_pro1_n
    s_waitcnt lgkmcnt(11)
    v_mfma_f32_32x32x16_bf16 v[80:95], v[24:27], v[112:115], 0
    s_waitcnt lgkmcnt(10)
    v_mfma_f32_32x32x16_bf16 v[80:95], v[28:31], v[116:119], v[80:95]
    s_waitcnt lgkmcnt(9)
    v_mfma_f32_32x32x16_bf16 v[80:95], v[32:35], v[120:123], v[80:95]
    s_waitcnt lgkmcnt(8)
    v_mfma_f32_32x32x16_bf16 v[80:95], v[36:39], v[124:127], v[80:95]
    s_waitcnt lgkmcnt(7)
    v_mfma_f32_32x32x16_bf16 v[80:95], v[40:43], v[128:131], v[80:95]
    s_waitcnt lgkmcnt(6)
    v_mfma_f32_32x32x16_bf16 v[80:95], v[44:47], v[132:135], v[80:95]
    s_waitcnt lgkmcnt(5)
    v_mfma_f32_32x32x16_bf16 v[80:95], v[48:51], v[136:139], v[80:95]
    s_waitcnt lgkmcnt(4)
    v_mfma_f32_32x32x16_bf16 v[80:95], v[52:55], v[140:143], v[80:95]
    s_waitcnt lgkmcnt(3)
    v_mfma_f32_32x32x16_bf16 v[80:95], v[56:59], v[144:147], v[80:95]
    s_waitcnt lgkmcnt(2)
    v_mfma_f32_32x32x16_bf16 v[80:95], v[60:63], v[148:151], v[80:95]
    s_waitcnt lgkmcnt(1)
    v_mfma_f32_32x32x16_bf16 v[80:95], v[64:67], v[152:155], v[80:95]
    s_waitcnt lgkmcnt(0)
    v_mfma_f32_32x32x16_bf16 v[80:95], v[68:71], v[156:159], v[80:95]
    v_add_u32 v11, s41, v9
    v_add_u32 v15, s41, v10
    v_xor_b32 v12, 32, v11
    v_xor_b32 v13, 64, v11
    v_xor_b32 v14, 96, v11
    v_xor_b32 v16, 64, v15
    s_mov_b32 s47, 0xd0800000
    s_barrier
    ds_read_b128 v[24:27], v11 offset:0
    ds_read_b128 v[28:31], v12 offset:0
    ds_read_b128 v[32:35], v13 offset:0
    ds_read_b128 v[36:39], v14 offset:0
    ds_read_b128 v[40:43], v11 offset:4096
    ds_read_b128 v[44:47], v12 offset:4096
    ds_read_b128 v[48:51], v13 offset:4096
    ds_read_b128 v[52:55], v14 offset:4096
    ds_read_b128 v[56:59], v11 offset:8192
    ds_read_b128 v[60:63], v12 offset:8192
    ds_read_b128 v[64:67], v13 offset:8192
    ds_read_b128 v[68:71], v14 offset:8192
    v_max3_f32 v21, v80, v81, v82
    v_max3_f32 v2, v83, v84, v85
    v_max3_f32 v21, v21, v86, v87
    v_max3_f32 v2, v2, v88, v89
    v_max3_f32 v21, v21, v90, v91
    v_max3_f32 v2, v2, v92, v93
    v_max3_f32 v21, v21, v94, v95
    v_max_f32 v21, v21, v2
    v_mov_b32 v2, v21
    s_nop 1
    v_permlane32_swap_b32 v2, v21
    s_nop 0
    v_max_f32 v21, v21, v2
    v_mul_f32 v23, s56, v21
    v_sub_f32 v23, 0, v23
    v_fma_f32 v1, v80, s56, v23
    v_fma_f32 v2, v81, s56, v23
    v_exp_f32 v1, v1
    v_fma_f32 v3, v82, s56, v23
    v_exp_f32 v2, v2
    v_fma_f32 v4, v83, s56, v23
    v_exp_f32 v3, v3
    v_add_f32 v20, v20, v1
    v_fma_f32 v5, v84, s56, v23
    v_exp_f32 v4, v4
    v_add_f32 v22, v22, v2
    v_fma_f32 v6, v85, s56, v23
    v_exp_f32 v5, v5
    v_cvt_pk_bf16_f32 v72, v1, v2
    v_add_f32 v20, v20, v3
    v_fma_f32 v7, v86, s56, v23
    v_exp_f32 v6, v6
    v_cvt_pk_bf16_f32 v73, v3, v4
    v_add_f32 v22, v22, v4
    v_fma_f32 v8, v87, s56, v23
    v_exp_f32 v7, v7
    v_add_f32 v20, v20, v5
    v_exp_f32 v8, v8
    v_cvt_pk_bf16_f32 v74, v5, v6
    v_add_f32 v22, v22, v6
    v_add_f32 v20, v20, v7
    v_cvt_pk_bf16_f32 v75, v7, v8
    v_add_f32 v22, v22, v8
    v_fma_f32 v1, v88, s56, v23
    v_fma_f32 v2, v89, s56, v23
    s_branch L_loop_n
L_pro1_n:
    s_waitcnt lgkmcnt(11)
    v_mfma_f32_32x32x16_bf16 v[96:111], v[24:27], v[112:115], 0
    s_waitcnt lgkmcnt(10)
    v_mfma_f32_32x32x16_bf16 v[96:111], v[28:31], v[116:119], v[96:111]
    s_waitcnt lgkmcnt(9)
    v_mfma_f32_32x32x16_bf16 v[96:111], v[32:35], v[120:123], v[96:111]
    s_waitcnt lgkmcnt(8)
    v_mfma_f32_32x32x16_bf16 v[96:111], v[36:39], v[124:127], v[96:111]
    s_waitcnt lgkmcnt(7)
    v_mfma_f32_32x32x16_bf16 v[96:111], v[40:43], v[128:131], v[96:111]
    s_waitcnt lgkmcnt(6)
    v_mfma_f32_32x32x16_bf16 v[96:111], v[44:47], v[132:135], v[96:111]
    s_waitcnt lgkmcnt(5)
    v_mfma_f32_32x32x16_bf16 v[96:111], v[48:51], v[136:139], v[96:111]
    s_waitcnt lgkmcnt(4)
    v_mfma_f32_32x32x16_bf16 v[96:111], v[52:55], v[140:143], v[96:111]
    s_waitcnt lgkmcnt(3)
    v_mfma_f32_32x32x16_bf16 v[96:111], v[56:59], v[144:147], v[96:111]
    s_waitcnt lgkmcnt(2)
    v_mfma_f32_32x32x16_bf16 v[96:111], v[60:63], v[148:151], v[96:111]
    s_waitcnt lgkmcnt(1)
    v_mfma_f32_32x32x16_bf16 v[96:111], v[64:67], v[152:155], v[96:111]
    s_waitcnt lgkmcnt(0)
    v_mfma_f32_32x32x16_bf16 v[96:111], v[68:71], v[156:159], v[96:111]
    v_add_u32 v11, s41, v9
    v_add_u32 v15, s41, v10
    v_xor_b32 v12, 32, v11
    v_xor_b32 v13, 64, v11
    v_xor_b32 v14, 96, v11
    v_xor_b32 v16, 64, v15
    s_mov_b32 s47, 0xd0800000
    s_barrier
    ds_read_b128 v[24:27], v11 offset:0
    ds_read_b128 v[28:31], v12 offset:0
    ds_read_b128 v[32:35], v13 offset:0
    ds_read_b128 v[36:39], v14 offset:0
    ds_read_b128 v[40:43], v11 offset:4096
    ds_read_b128 v[44:47], v12 offset:4096
    ds_read_b128 v[48:51], v13 offset:4096
    ds_read_b128 v[52:55], v14 offset:4096
    ds_read_b128 v[56:59], v11 offset:8192
    ds_read_b128 v[60:63], v12 offset:8192
    ds_read_b128 v[64:67], v13 offset:8192
    ds_read_b128 v[68:71], v14 offset:8192
    v_max3_f32 v21, v96, v97, v98
    v_max3_f32 v2, v99, v100, v101
    v_max3_f32 v21, v21, v102, v103
    v_max3_f32 v2, v2, v104, v105
    v_max3_f32 v21, v21, v106, v107
    v_max3_f32 v2, v2, v108, v109
    v_max3_f32 v21, v21, v110, v111
    v_max_f32 v21, v21, v2
    v_mov_b32 v2, v21
    s_nop 1
    v_permlane32_swap_b32 v2, v21
    s_nop 0
    v_max_f32 v21, v21, v2
    v_mul_f32 v23, s56, v21
    v_sub_f32 v23, 0, v23
    v_fma_f32 v1, v96, s56, v23
    v_fma_f32 v2, v97, s56, v23
    v_exp_f32 v1, v1
    v_fma_f32 v3, v98, s56, v23
    v_exp_f32 v2, v2
    v_fma_f32 v4, v99, s56, v23
    v_exp_f32 v3, v3
    v_add_f32 v20, v20, v1
    v_fma_f32 v5, v100, s56, v23
    v_exp_f32 v4, v4
    v_add_f32 v22, v22, v2
    v_fma_f32 v6, v101, s56, v23
    v_exp_f32 v5, v5
    v_cvt_pk_bf16_f32 v72, v1, v2
    v_add_f32 v20, v20, v3
    v_fma_f32 v7, v102, s56, v23
    v_exp_f32 v6, v6
    v_cvt_pk_bf16_f32 v73, v3, v4
    v_add_f32 v22, v22, v4
    v_fma_f32 v8, v103, s56, v23
    v_exp_f32 v7, v7
    v_add_f32 v20, v20, v5
    v_exp_f32 v8, v8
    v_cvt_pk_bf16_f32 v74, v5, v6
    v_add_f32 v22, v22, v6
    v_add_f32 v20, v20, v7
    v_cvt_pk_bf16_f32 v75, v7, v8
    v_add_f32 v22, v22, v8
    v_fma_f32 v1, v104, s56, v23
    v_fma_f32 v2, v105, s56, v23
    s_branch L_mid_n
.p2align 6
    s_nop 0
L_loop_n:
    s_waitcnt lgkmcnt(6)
    v_mfma_f32_32x32x16_bf16 v[96:111], v[24:27], v[112:115], 0
    ds_read_b64_tr_b16 v[24:25], v15 offset:12288
    ds_read_b64_tr_b16 v[26:27], v15 offset:13312
    v_exp_f32 v1, v1
    v_fma_f32 v3, v90, s56, v23
    v_mfma_f32_32x32x16_bf16 v[96:111], v[28:31], v[116:119], v[96:111]
    ds_read_b64_tr_b16 v[28:29], v16 offset:12288
    ds_read_b64_tr_b16 v[30:31], v16 offset:13312
    v_exp_f32 v2, v2
    v_fma_f32 v4, v91, s56, v23
    v_mfma_f32_32x32x16_bf16 v[96:111], v[32:35], v[120:123], v[96:111]
    ds_read_b64_tr_b16 v[32:33], v15 offset:16384
    ds_read_b64_tr_b16 v[34:35], v15 offset:17408
    v_exp_f32 v3, v3
    v_add_f32 v20, v20, v1
    v_fma_f32 v5, v92, s56, v23
    v_mfma_f32_32x32x16_bf16 v[96:111], v[36:39], v[124:127], v[96:111]
    ds_read_b64_tr_b16 v[36:37], v16 offset:16384
    ds_read_b64_tr_b16 v[38:39], v16 offset:17408
    v_exp_f32 v4, v4
    v_add_f32 v22, v22, v2
    v_mfma_f32_32x32x16_bf16 v[96:111], v[40:43], v[128:131], v[96:111]
    ds_read_b64_tr_b16 v[40:41], v15 offset:20480
    ds_read_b64_tr_b16 v[42:43], v15 offset:21504
    v_fma_f32 v6, v93, s56, v23
    v_exp_f32 v5, v5
    v_mfma_f32_32x32x16_bf16 v[96:111], v[44:47], v[132:135], v[96:111]
    ds_read_b64_tr_b16 v[44:45], v16 offset:20480
    ds_read_b64_tr_b16 v[46:47], v16 offset:21504
    v_cvt_pk_bf16_f32 v76, v1, v2
    v_add_f32 v20, v20, v3
    v_fma_f32 v7, v94, s56, v23
    s_waitcnt lgkmcnt(12)
    v_mfma_f32_32x32x16_bf16 v[96:111], v[48:51], v[136:139], v[96:111]
    ds_read_b64_tr_b16 v[48:49], v15 offset:14336
    ds_read_b64_tr_b16 v[50:51], v15 offset:15360
    v_exp_f32 v6, v6
    v_cvt_pk_bf16_f32 v77, v3, v4
    v_mfma_f32_32x32x16_bf16 v[96:111], v[52:55], v[140:143], v[96:111]
    ds_read_b64_tr_b16 v[52:53], v16 offset:14336
    ds_read_b64_tr_b16 v[54:55], v16 offset:15360
    v_add_f32 v22, v22, v4
    v_fma_f32 v8, v95, s56, v23
    v_mfma_f32_32x32x16_bf16 v[96:111], v[56:59], v[144:147], v[96:111]
    ds_read_b64_tr_b16 v[56:57], v15 offset:18432
    ds_read_b64_tr_b16 v[58:59], v15 offset:19456
    v_exp_f32 v7, v7
    v_add_f32 v20, v20, v5
    v_mfma_f32_32x32x16_bf16 v[96:111], v[60:63], v[148:151], v[96:111]
    ds_read_b64_tr_b16 v[60:61], v16 offset:18432
    ds_read_b64_tr_b16 v[62:63], v16 offset:19456
    v_exp_f32 v8, v8
    v_cvt_pk_bf16_f32 v78, v5, v6
    v_add_f32 v22, v22, v6
    v_mfma_f32_32x32x16_bf16 v[96:111], v[64:67], v[152:155], v[96:111]
    ds_read_b64_tr_b16 v[64:65], v15 offset:22528
    ds_read_b64_tr_b16 v[66:67], v15 offset:23552
    v_add_f32 v20, v20, v7
    v_cvt_pk_bf16_f32 v79, v7, v8
    v_add_f32 v22, v22, v8
    v_mfma_f32_32x32x16_bf16 v[96:111], v[68:71], v[156:159], v[96:111]
    ds_read_b64_tr_b16 v[68:69], v16 offset:22528
    ds_read_b64_tr_b16 v[70:71], v16 offset:23552
    s_add_u32 s41, s41, s38
    s_sub_u32 s31, s41, 147456
    s_cselect_b32 s41, s41, s31
    s_waitcnt lgkmcnt(12)
    v_mfma_f32_32x32x16_bf16 v[160:175], v[24:27], v[72:75], v[160:175]
    v_add_u32 v11, s41, v9
    v_add_u32 v15, s41, v10
    v_xor_b32 v12, 32, v11
    v_xor_b32 v13, 64, v11
    v_xor_b32 v14, 96, v11
    v_xor_b32 v16, 64, v15
    v_mfma_f32_32x32x16_bf16 v[176:191], v[28:31], v[72:75], v[176:191]
    s_waitcnt lgkmcnt(0)
    s_barrier
    ds_read_b128 v[24:27], v11 offset:0
    ds_read_b128 v[28:31], v12 offset:0
    v_mfma_f32_32x32x16_bf16 v[192:207], v[32:35], v[72:75], v[192:207]
    ds_read_b128 v[32:35], v13 offset:0
    v_fma_f32 v1, v96, s56, v23
    v_fma_f32 v2, v97, s56, v23
    v_exp_f32 v1, v1
    v_mfma_f32_32x32x16_bf16 v[208:223], v[36:39], v[72:75], v[208:223]
    ds_read_b128 v[36:39], v14 offset:0
    v_fma_f32 v3, v98, s56, v23
    v_exp_f32 v2, v2
    v_fma_f32 v4, v99, s56, v23
    v_mfma_f32_32x32x16_bf16 v[224:239], v[40:43], v[72:75], v[224:239]
    ds_read_b128 v[40:43], v11 offset:4096
    v_exp_f32 v3, v3
    v_add_f32 v20, v20, v1
    v_fma_f32 v5, v100, s56, v23
    v_mfma_f32_32x32x16_bf16 v[240:255], v[44:47], v[72:75], v[240:255]
    ds_read_b128 v[44:47], v12 offset:4096
    v_exp_f32 v4, v4
    v_add_f32 v22, v22, v2
    v_fma_f32 v6, v101, s56, v23
    v_mfma_f32_32x32x16_bf16 v[160:175], v[48:51], v[76:79], v[160:175]
    ds_read_b128 v[48:51], v13 offset:4096
    v_exp_f32 v5, v5
    v_cvt_pk_bf16_f32 v72, v1, v2
    v_add_f32 v20, v20, v3
    v_mfma_f32_32x32x16_bf16 v[176:191], v[52:55], v[76:79], v[176:191]
    ds_read_b128 v[52:55], v14 offset:4096
    v_fma_f32 v7, v102, s56, v23
    v_exp_f32 v6, v6
    v_cvt_pk_bf16_f32 v73, v3, v4
    v_mfma_f32_32x32x16_bf16 v[192:207], v[56:59], v[76:79], v[192:207]
    ds_read_b128 v[56:59], v11 offset:8192
    v_add_f32 v22, v22, v4
    v_fma_f32 v8, v103, s56, v23
    v_exp_f32 v7, v7
    v_mfma_f32_32x32x16_bf16 v[208:223], v[60:63], v[76:79], v[208:223]
    ds_read_b128 v[60:63], v12 offset:8192
    v_add_f32 v20, v20, v5
    v_exp_f32 v8, v8
    v_cvt_pk_bf16_f32 v74, v5, v6
    v_mfma_f32_32x32x16_bf16 v[224:239], v[64:67], v[76:79], v[224:239]
    ds_read_b128 v[64:67], v13 offset:8192
    v_add_f32 v22, v22, v6
    v_add_f32 v20, v20, v7
    v_cvt_pk_bf16_f32 v75, v7, v8
    v_add_f32 v22, v22, v8
    v_mfma_f32_32x32x16_bf16 v[240:255], v[68:71], v[76:79], v[240:255]
    ds_read_b128 v[68:71], v14 offset:8192
    v_fma_f32 v1, v104, s56, v23
    v_fma_f32 v2, v105, s56, v23
L_mid_n:
    s_waitcnt lgkmcnt(6)
    v_mfma_f32_32x32x16_bf16 v[80:95], v[24:27], v[112:115], 0
    ds_read_b64_tr_b16 v[24:25], v15 offset:12288
    ds_read_b64_tr_b16 v[26:27], v15 offset:13312
    v_exp_f32 v1, v1
    v_fma_f32 v3, v106, s56, v23
    v_mfma_f32_32x32x16_bf16 v[80:95], v[28:31], v[116:119], v[80:95]
    ds_read_b64_tr_b16 v[28:29], v16 offset:12288
    ds_read_b64_tr_b16 v[30:31], v16 offset:13312
    v_exp_f32 v2, v2
    v_fma_f32 v4, v107, s56, v23
    v_mfma_f32_32x32x16_bf16 v[80:95], v[32:35], v[120:123], v[80:95]
    ds_read_b64_tr_b16 v[32:33], v15 offset:16384
    ds_read_b64_tr_b16 v[34:35], v15 offset:17408
    v_exp_f32 v3, v3
    v_add_f32 v20, v20, v1
    v_fma_f32 v5, v108, s56, v23
    v_mfma_f32_32x32x16_bf16 v[80:95], v[36:39], v[124:127], v[80:95]
    ds_read_b64_tr_b16 v[36:37], v16 offset:16384
    ds_read_b64_tr_b16 v[38:39], v16 offset:17408
    v_exp_f32 v4, v4
    v_add_f32 v22, v22, v2
    v_mfma_f32_32x32x16_bf16 v[80:95], v[40:43], v[128:131], v[80:95]
    ds_read_b64_tr_b16 v[40:41], v15 offset:20480
    ds_read_b64_tr_b16 v[42:43], v15 offset:21504
    v_fma_f32 v6, v109, s56, v23
    v_exp_f32 v5, v5
    v_mfma_f32_32x32x16_bf16 v[80:95], v[44:47], v[132:135], v[80:95]
    ds_read_b64_tr_b16 v[44:45], v16 offset:20480
    ds_read_b64_tr_b16 v[46:47], v16 offset:21504
    v_cvt_pk_bf16_f32 v76, v1, v2
    v_add_f32 v20, v20, v3
    v_fma_f32 v7, v110, s56, v23
    s_waitcnt lgkmcnt(12)
    v_mfma_f32_32x32x16_bf16 v[80:95], v[48:51], v[136:139], v[80:95]
    ds_read_b64_tr_b16 v[48:49], v15 offset:14336
    ds_read_b64_tr_b16 v[50:51], v15 offset:15360
    v_exp_f32 v6, v6
    v_cvt_pk_bf16_f32 v77, v3, v4
    v_mfma_f32_32x32x16_bf16 v[80:95], v[52:55], v[140:143], v[80:95]
    ds_read_b64_tr_b16 v[52:53], v16 offset:14336
    ds_read_b64_tr_b16 v[54:55], v16 offset:15360
    v_add_f32 v22, v22, v4
    v_fma_f32 v8, v111, s56, v23
    v_mfma_f32_32x32x16_bf16 v[80:95], v[56:59], v[144:147], v[80:95]
    ds_read_b64_tr_b16 v[56:57], v15 offset:18432
    ds_read_b64_tr_b16 v[58:59], v15 offset:19456
    v_exp_f32 v7, v7
    v_add_f32 v20, v20, v5
    v_mfma_f32_32x32x16_bf16 v[80:95], v[60:63], v[148:151], v[80:95]
    ds_read_b64_tr_b16 v[60:61], v16 offset:18432
    ds_read_b64_tr_b16 v[62:63], v16 offset:19456
    v_exp_f32 v8, v8
    v_cvt_pk_bf16_f32 v78, v5, v6
    v_add_f32 v22, v22, v6
    v_mfma_f32_32x32x16_bf16 v[80:95], v[64:67], v[152:155], v[80:95]
    ds_read_b64_tr_b16 v[64:65], v15 offset:22528
    ds_read_b64_tr_b16 v[66:67], v15 offset:23552
    v_add_f32 v20, v20, v7
    v_cvt_pk_bf16_f32 v79, v7, v8
    v_add_f32 v22, v22, v8
    v_mfma_f32_32x32x16_bf16 v[80:95], v[68:71], v[156:159], v[80:95]
    ds_read_b64_tr_b16 v[68:69], v16 offset:22528
    ds_read_b64_tr_b16 v[70:71], v16 offset:23552
    s_add_u32 s41, s41, s38
    s_sub_u32 s31, s41, 147456
    s_cselect_b32 s41, s41, s31
    s_waitcnt lgkmcnt(12)
    v_mfma_f32_32x32x16_bf16 v[160:175], v[24:27], v[72:75], v[160:175]
    v_add_u32 v11, s41, v9
    v_add_u32 v15, s41, v10
    v_xor_b32 v12, 32, v11
    v_xor_b32 v13, 64, v11
    v_xor_b32 v14, 96, v11
    v_xor_b32 v16, 64, v15
    v_mfma_f32_32x32x16_bf16 v[176:191], v[28:31], v[72:75], v[176:191]
    s_waitcnt lgkmcnt(0)
    s_barrier
    ds_read_b128 v[24:27], v11 offset:0
    ds_read_b128 v[28:31], v12 offset:0
    v_mfma_f32_32x32x16_bf16 v[192:207], v[32:35], v[72:75], v[192:207]
    ds_read_b128 v[32:35], v13 offset:0
    v_fma_f32 v1, v80, s56, v23
    v_fma_f32 v2, v81, s56, v23
    v_exp_f32 v1, v1
    v_mfma_f32_32x32x16_bf16 v[208:223], v[36:39], v[72:75], v[208:223]
    ds_read_b128 v[36:39], v14 offset:0
    v_fma_f32 v3, v82, s56, v23
    v_exp_f32 v2, v2
    v_fma_f32 v4, v83, s56, v23
    v_mfma_f32_32x32x16_bf16 v[224:239], v[40:43], v[72:75], v[224:239]
    ds_read_b128 v[40:43], v11 offset:4096
    v_exp_f32 v3, v3
    v_add_f32 v20, v20, v1
    v_fma_f32 v5, v84, s56, v23
    v_mfma_f32_32x32x16_bf16 v[240:255], v[44:47], v[72:75], v[240:255]
    ds_read_b128 v[44:47], v12 offset:4096
    v_exp_f32 v4, v4
    v_add_f32 v22, v22, v2
    v_fma_f32 v6, v85, s56, v23
    v_mfma_f32_32x32x16_bf16 v[160:175], v[48:51], v[76:79], v[160:175]
    ds_read_b128 v[48:51], v13 offset:4096
    v_exp_f32 v5, v5
    v_cvt_pk_bf16_f32 v72, v1, v2
    v_add_f32 v20, v20, v3
    v_mfma_f32_32x32x16_bf16 v[176:191], v[52:55], v[76:79], v[176:191]
    ds_read_b128 v[52:55], v14 offset:4096
    v_fma_f32 v7, v86, s56, v23
    v_exp_f32 v6, v6
    v_cvt_pk_bf16_f32 v73, v3, v4
    v_mfma_f32_32x32x16_bf16 v[192:207], v[56:59], v[76:79], v[192:207]
    ds_read_b128 v[56:59], v11 offset:8192
    v_add_f32 v22, v22, v4
    v_fma_f32 v8, v87, s56, v23
    v_exp_f32 v7, v7
    v_mfma_f32_32x32x16_bf16 v[208:223], v[60:63], v[76:79], v[208:223]
    ds_read_b128 v[60:63], v12 offset:8192
    v_add_f32 v20, v20, v5
    v_exp_f32 v8, v8
    v_cvt_pk_bf16_f32 v74, v5, v6
    v_mfma_f32_32x32x16_bf16 v[224:239], v[64:67], v[76:79], v[224:239]
    ds_read_b128 v[64:67], v13 offset:8192
    v_add_f32 v22, v22, v6
    v_add_f32 v20, v20, v7
    v_cvt_pk_bf16_f32 v75, v7, v8
    v_add_f32 v22, v22, v8
    v_mfma_f32_32x32x16_bf16 v[240:255], v[68:71], v[76:79], v[240:255]
    s_sub_u32 s51, s51, 1
    s_cmp_lg_u32 s51, 0
    ds_read_b128 v[68:71], v14 offset:8192
    v_fma_f32 v1, v88, s56, v23
    v_fma_f32 v2, v89, s56, v23
    s_cbranch_scc1 L_loop_n
    ds_read_b64_tr_b16 v[24:25], v15 offset:12288
    ds_read_b64_tr_b16 v[26:27], v15 offset:13312
    ds_read_b64_tr_b16 v[28:29], v16 offset:12288
    ds_read_b64_tr_b16 v[30:31], v16 offset:13312
    ds_read_b64_tr_b16 v[32:33], v15 offset:16384
    ds_read_b64_tr_b16 v[34:35], v15 offset:17408
    ds_read_b64_tr_b16 v[36:37], v16 offset:16384
    ds_read_b64_tr_b16 v[38:39], v16 offset:17408
    ds_read_b64_tr_b16 v[40:41], v15 offset:20480
    ds_read_b64_tr_b16 v[42:43], v15 offset:21504
    ds_read_b64_tr_b16 v[44:45], v16 offset:20480
    ds_read_b64_tr_b16 v[46:47], v16 offset:21504
    s_cmp_gt_u32 s44, 16
    s_cbranch_scc1 L_long_n
    s_waitcnt lgkmcnt(6)
    v_mfma_f32_32x32x16_bf16 v[160:175], v[24:27], v[72:75], v[160:175]
    v_add_f32 v20, v20, v22
    s_add_u32 s90, s41, s43
    v_exp_f32 v6, v23
    v_mov_b32 v1, v20
    s_sub_u32 s30, s90, 147456
    s_cselect_b32 s90, s90, s30
    v_and_b32 v2, 31, v0
    v_mfma_f32_32x32x16_bf16 v[176:191], v[28:31], v[72:75], v[176:191]
    v_permlane32_swap_b32 v1, v20
    v_lshrrev_b32 v3, 5, v0
    v_add_f32 v20, v20, v1
    v_mul_f32 v6, s46, v6
    v_lshlrev_b32 v4, 7, v2
    v_and_b32 v2, 7, v2
    v_fma_f32 v7, v6, s47, v20
    v_mfma_f32_32x32x16_bf16 v[192:207], v[32:35], v[72:75], v[192:207]
    v_add_f32 v20, v20, v6
    v_lshl_add_u32 v4, v2, 4, v4
    v_cmp_nge_f32 vcc, s57, v7
    v_rcp_f32 v20, v20
    v_lshl_add_u32 v4, v3, 3, v4
    v_add_u32 v112, s90, v4
    v_mov_b32 v21, v20
    s_waitcnt lgkmcnt(4)
    v_mfma_f32_32x32x16_bf16 v[208:223], v[36:39], v[72:75], v[208:223]
    v_xor_b32 v113, 16, v112
    v_xor_b32 v114, 32, v112
    v_xor_b32 v115, 48, v112
    v_xor_b32 v116, 64, v112
    v_xor_b32 v117, 80, v112
    v_xor_b32 v118, 96, v112
    v_xor_b32 v119, 112, v112
    s_waitcnt lgkmcnt(2)
    v_mfma_f32_32x32x16_bf16 v[224:239], v[40:43], v[72:75], v[224:239]
    v_lshlrev_b32 v5, 4, v0
    v_lshrrev_b32 v1, 3, v0
    v_and_b32 v2, 7, v0
    v_add_u32 v120, s90, v5
    v_xor_b32 v2, v2, v1
    v_mul_u32_u24 v1, 6144, v1
    v_lshl_add_u32 v1, v2, 4, v1
    s_waitcnt lgkmcnt(0)
    v_mfma_f32_32x32x16_bf16 v[240:255], v[44:47], v[72:75], v[240:255]
    v_add_u32 v121, s34, v1
    v_add_u32 v122, 49152, v121
    v_add_u32 v123, 98304, v121
    v_add_u32 v124, 147456, v121
    s_branch L_epi
L_long_n:
    s_waitcnt lgkmcnt(6)
    v_mfma_f32_32x32x16_bf16 v[160:175], v[24:27], v[72:75], v[160:175]
    ds_read_b64_tr_b16 v[48:49], v15 offset:14336
    ds_read_b64_tr_b16 v[50:51], v15 offset:15360
    v_exp_f32 v1, v1
    v_fma_f32 v3, v90, s56, v23
    v_exp_f32 v2, v2
    v_fma_f32 v4, v91, s56, v23
    v_exp_f32 v3, v3
    v_mfma_f32_32x32x16_bf16 v[176:191], v[28:31], v[72:75], v[176:191]
    ds_read_b64_tr_b16 v[52:53], v16 offset:14336
    ds_read_b64_tr_b16 v[54:55], v16 offset:15360
    v_add_f32 v20, v20, v1
    v_fma_f32 v5, v92, s56, v23
    v_exp_f32 v4, v4
    v_add_f32 v22, v22, v2
    v_fma_f32 v6, v93, s56, v23
    v_mfma_f32_32x32x16_bf16 v[192:207], v[32:35], v[72:75], v[192:207]
    ds_read_b64_tr_b16 v[56:57], v15 offset:18432
    ds_read_b64_tr_b16 v[58:59], v15 offset:19456
    v_exp_f32 v5, v5
    v_cvt_pk_bf16_f32 v76, v1, v2
    v_add_f32 v20, v20, v3
    v_fma_f32 v7, v94, s56, v23
    v_exp_f32 v6, v6
    s_waitcnt lgkmcnt(6)
    v_mfma_f32_32x32x16_bf16 v[208:223], v[36:39], v[72:75], v[208:223]
    ds_read_b64_tr_b16 v[60:61], v16 offset:18432
    ds_read_b64_tr_b16 v[62:63], v16 offset:19456
    v_cvt_pk_bf16_f32 v77, v3, v4
    v_add_f32 v22, v22, v4
    v_fma_f32 v8, v95, s56, v23
    v_exp_f32 v7, v7
    v_add_f32 v20, v20, v5
    v_mfma_f32_32x32x16_bf16 v[224:239], v[40:43], v[72:75], v[224:239]
    ds_read_b64_tr_b16 v[64:65], v15 offset:22528
    ds_read_b64_tr_b16 v[66:67], v15 offset:23552
    v_exp_f32 v8, v8
    v_cvt_pk_bf16_f32 v78, v5, v6
    v_add_f32 v22, v22, v6
    v_add_f32 v20, v20, v7
    v_cvt_pk_bf16_f32 v79, v7, v8
    v_mfma_f32_32x32x16_bf16 v[240:255], v[44:47], v[72:75], v[240:255]
    ds_read_b64_tr_b16 v[68:69], v16 offset:22528
    ds_read_b64_tr_b16 v[70:71], v16 offset:23552
    v_add_f32 v22, v22, v8
    s_nop 0
    s_waitcnt lgkmcnt(6)
    v_mfma_f32_32x32x16_bf16 v[160:175], v[48:51], v[76:79], v[160:175]
    v_add_f32 v20, v20, v22
    s_add_u32 s90, s41, s43
    v_exp_f32 v6, v23
    v_mov_b32 v1, v20
    s_sub_u32 s30, s90, 147456
    s_cselect_b32 s90, s90, s30
    v_and_b32 v2, 31, v0
    v_mfma_f32_32x32x16_bf16 v[176:191], v[52:55], v[76:79], v[176:191]
    v_permlane32_swap_b32 v1, v20
    v_lshrrev_b32 v3, 5, v0
    v_add_f32 v20, v20, v1
    v_mul_f32 v6, s46, v6
    v_lshlrev_b32 v4, 7, v2
    v_and_b32 v2, 7, v2
    v_fma_f32 v7, v6, s47, v20
    v_mfma_f32_32x32x16_bf16 v[192:207], v[56:59], v[76:79], v[192:207]
    v_add_f32 v20, v20, v6
    v_lshl_add_u32 v4, v2, 4, v4
    v_cmp_nge_f32 vcc, s57, v7
    v_rcp_f32 v20, v20
    v_lshl_add_u32 v4, v3, 3, v4
    v_add_u32 v112, s90, v4
    v_mov_b32 v21, v20
    s_waitcnt lgkmcnt(4)
    v_mfma_f32_32x32x16_bf16 v[208:223], v[60:63], v[76:79], v[208:223]
    v_xor_b32 v113, 16, v112
    v_xor_b32 v114, 32, v112
    v_xor_b32 v115, 48, v112
    v_xor_b32 v116, 64, v112
    v_xor_b32 v117, 80, v112
    v_xor_b32 v118, 96, v112
    v_xor_b32 v119, 112, v112
    s_waitcnt lgkmcnt(2)
    v_mfma_f32_32x32x16_bf16 v[224:239], v[64:67], v[76:79], v[224:239]
    v_lshlrev_b32 v5, 4, v0
    v_lshrrev_b32 v1, 3, v0
    v_and_b32 v2, 7, v0
    v_add_u32 v120, s90, v5
    v_xor_b32 v2, v2, v1
    v_mul_u32_u24 v1, 6144, v1
    v_lshl_add_u32 v1, v2, 4, v1
    s_waitcnt lgkmcnt(0)
    v_mfma_f32_32x32x16_bf16 v[240:255], v[68:71], v[76:79], v[240:255]
    v_add_u32 v121, s34, v1
    v_add_u32 v122, 49152, v121
    v_add_u32 v123, 98304, v121
    v_add_u32 v124, 147456, v121
L_epi:
    s_cbranch_vccnz L_solo
L_epi2:
    v_pk_mul_f32 v[160:161], v[160:161], v[20:21]
    v_pk_mul_f32 v[162:163], v[162:163], v[20:21]
    v_cvt_pk_bf16_f32 v72, v160, v161
    v_cvt_pk_bf16_f32 v73, v162, v163
    ds_write_b64 v112, v[72:73] offset:0
    v_pk_mul_f32 v[164:165], v[164:165], v[20:21]
    v_pk_mul_f32 v[166:167], v[166:167], v[20:21]
    v_cvt_pk_bf16_f32 v74, v164, v165
    v_cvt_pk_bf16_f32 v75, v166, v167
    ds_write_b64 v113, v[74:75] offset:0
    v_pk_mul_f32 v[168:169], v[168:169], v[20:21]
    v_pk_mul_f32 v[170:171], v[170:171], v[20:21]
    v_cvt_pk_bf16_f32 v76, v168, v169
    v_cvt_pk_bf16_f32 v77, v170, v171
    ds_write_b64 v114, v[76:77] offset:0
    v_pk_mul_f32 v[172:173], v[172:173], v[20:21]
    v_pk_mul_f32 v[174:175], v[174:175], v[20:21]
    v_cvt_pk_bf16_f32 v78, v172, v173
    v_cvt_pk_bf16_f32 v79, v174, v175
    ds_write_b64 v115, v[78:79] offset:0
    v_pk_mul_f32 v[176:177], v[176:177], v[20:21]
    v_pk_mul_f32 v[178:179], v[178:179], v[20:21]
    v_cvt_pk_bf16_f32 v72, v176, v177
    v_cvt_pk_bf16_f32 v73, v178, v179
    ds_write_b64 v116, v[72:73] offset:0
    v_pk_mul_f32 v[180:181], v[180:181], v[20:21]
    v_pk_mul_f32 v[182:183], v[182:183], v[20:21]
    v_cvt_pk_bf16_f32 v74, v180, v181
    v_cvt_pk_bf16_f32 v75, v182, v183
    ds_write_b64 v117, v[74:75] offset:0
    v_pk_mul_f32 v[184:185], v[184:185], v[20:21]
    v_pk_mul_f32 v[186:187], v[186:187], v[20:21]
    v_cvt_pk_bf16_f32 v76, v184, v185
    v_cvt_pk_bf16_f32 v77, v186, v187
    ds_write_b64 v118, v[76:77] offset:0
    v_pk_mul_f32 v[188:189], v[188:189], v[20:21]
    v_pk_mul_f32 v[190:191], v[190:191], v[20:21]
    v_cvt_pk_bf16_f32 v78, v188, v189
    v_cvt_pk_bf16_f32 v79, v190, v191
    ds_write_b64 v119, v[78:79] offset:0
    ds_read_b128 v[80:83], v120 offset:0
    ds_read_b128 v[84:87], v120 offset:1024
    ds_read_b128 v[88:91], v120 offset:2048
    ds_read_b128 v[92:95], v120 offset:3072
    v_pk_mul_f32 v[192:193], v[192:193], v[20:21]
    v_pk_mul_f32 v[194:195], v[194:195], v[20:21]
    v_cvt_pk_bf16_f32 v72, v192, v193
    v_cvt_pk_bf16_f32 v73, v194, v195
    ds_write_b64 v112, v[72:73] offset:4096
    v_pk_mul_f32 v[196:197], v[196:197], v[20:21]
    v_pk_mul_f32 v[198:199], v[198:199], v[20:21]
    v_cvt_pk_bf16_f32 v74, v196, v197
    v_cvt_pk_bf16_f32 v75, v198, v199
    ds_write_b64 v113, v[74:75] offset:4096
    v_pk_mul_f32 v[200:201], v[200:201], v[20:21]
    v_pk_mul_f32 v[202:203], v[202:203], v[20:21]
    v_cvt_pk_bf16_f32 v76, v200, v201
    v_cvt_pk_bf16_f32 v77, v202, v203
    ds_write_b64 v114, v[76:77] offset:4096
    s_waitcnt lgkmcnt(6)
    buffer_store_dwordx4 v[80:83], v121, s[24:27], 0 offen offset:0 nt
    s_waitcnt lgkmcnt(5)
    buffer_store_dwordx4 v[84:87], v122, s[24:27], 0 offen offset:0 nt
    s_waitcnt lgkmcnt(4)
    buffer_store_dwordx4 v[88:91], v123, s[24:27], 0 offen offset:0 nt
    s_waitcnt lgkmcnt(3)
    buffer_store_dwordx4 v[92:95], v124, s[24:27], 0 offen offset:0 nt
    v_pk_mul_f32 v[204:205], v[204:205], v[20:21]
    v_pk_mul_f32 v[206:207], v[206:207], v[20:21]
    v_cvt_pk_bf16_f32 v78, v204, v205
    v_cvt_pk_bf16_f32 v79, v206, v207
    ds_write_b64 v115, v[78:79] offset:4096
    v_pk_mul_f32 v[208:209], v[208:209], v[20:21]
    v_pk_mul_f32 v[210:211], v[210:211], v[20:21]
    v_cvt_pk_bf16_f32 v72, v208, v209
    v_cvt_pk_bf16_f32 v73, v210, v211
    ds_write_b64 v116, v[72:73] offset:4096
    v_pk_mul_f32 v[212:213], v[212:213], v[20:21]
    v_pk_mul_f32 v[214:215], v[214:215], v[20:21]
    v_cvt_pk_bf16_f32 v74, v212, v213
    v_cvt_pk_bf16_f32 v75, v214, v215
    ds_write_b64 v117, v[74:75] offset:4096
    v_pk_mul_f32 v[216:217], v[216:217], v[20:21]
    v_pk_mul_f32 v[218:219], v[218:219], v[20:21]
    v_cvt_pk_bf16_f32 v76, v216, v217
    v_cvt_pk_bf16_f32 v77, v218, v219
    ds_write_b64 v118, v[76:77] offset:4096
    v_pk_mul_f32 v[220:221], v[220:221], v[20:21]
    v_pk_mul_f32 v[222:223], v[222:223], v[20:21]
    v_cvt_pk_bf16_f32 v78, v220, v221
    v_cvt_pk_bf16_f32 v79, v222, v223
    ds_write_b64 v119, v[78:79] offset:4096
    ds_read_b128 v[96:99], v120 offset:4096
    ds_read_b128 v[100:103], v120 offset:5120
    ds_read_b128 v[104:107], v120 offset:6144
    ds_read_b128 v[108:111], v120 offset:7168
    v_pk_mul_f32 v[224:225], v[224:225], v[20:21]
    v_pk_mul_f32 v[226:227], v[226:227], v[20:21]
    v_cvt_pk_bf16_f32 v72, v224, v225
    v_cvt_pk_bf16_f32 v73, v226, v227
    ds_write_b64 v112, v[72:73] offset:8192
    v_pk_mul_f32 v[228:229], v[228:229], v[20:21]
    v_pk_mul_f32 v[230:231], v[230:231], v[20:21]
    v_cvt_pk_bf16_f32 v74, v228, v229
    v_cvt_pk_bf16_f32 v75, v230, v231
    ds_write_b64 v113, v[74:75] offset:8192
    v_pk_mul_f32 v[232:233], v[232:233], v[20:21]
    v_pk_mul_f32 v[234:235], v[234:235], v[20:21]
    v_cvt_pk_bf16_f32 v76, v232, v233
    v_cvt_pk_bf16_f32 v77, v234, v235
    ds_write_b64 v114, v[76:77] offset:8192
    s_waitcnt lgkmcnt(6)
    buffer_store_dwordx4 v[96:99], v121, s[24:27], 0 offen offset:128 nt
    s_waitcnt lgkmcnt(5)
    buffer_store_dwordx4 v[100:103], v122, s[24:27], 0 offen offset:128 nt
    s_waitcnt lgkmcnt(4)
    buffer_store_dwordx4 v[104:107], v123, s[24:27], 0 offen offset:128 nt
    s_waitcnt lgkmcnt(3)
    buffer_store_dwordx4 v[108:111], v124, s[24:27], 0 offen offset:128 nt
    v_pk_mul_f32 v[236:237], v[236:237], v[20:21]
    v_pk_mul_f32 v[238:239], v[238:239], v[20:21]
    v_cvt_pk_bf16_f32 v78, v236, v237
    v_cvt_pk_bf16_f32 v79, v238, v239
    ds_write_b64 v115, v[78:79] offset:8192
    v_pk_mul_f32 v[240:241], v[240:241], v[20:21]
    v_pk_mul_f32 v[242:243], v[242:243], v[20:21]
    v_cvt_pk_bf16_f32 v72, v240, v241
    v_cvt_pk_bf16_f32 v73, v242, v243
    ds_write_b64 v116, v[72:73] offset:8192
    v_pk_mul_f32 v[244:245], v[244:245], v[20:21]
    v_pk_mul_f32 v[246:247], v[246:247], v[20:21]
    v_cvt_pk_bf16_f32 v74, v244, v245
    v_cvt_pk_bf16_f32 v75, v246, v247
    ds_write_b64 v117, v[74:75] offset:8192
    v_pk_mul_f32 v[248:249], v[248:249], v[20:21]
    v_pk_mul_f32 v[250:251], v[250:251], v[20:21]
    v_cvt_pk_bf16_f32 v76, v248, v249
    v_cvt_pk_bf16_f32 v77, v250, v251
    ds_write_b64 v118, v[76:77] offset:8192
    v_pk_mul_f32 v[252:253], v[252:253], v[20:21]
    v_pk_mul_f32 v[254:255], v[254:255], v[20:21]
    v_cvt_pk_bf16_f32 v78, v252, v253
    v_cvt_pk_bf16_f32 v79, v254, v255
    ds_write_b64 v119, v[78:79] offset:8192
    ds_read_b128 v[80:83], v120 offset:8192
    ds_read_b128 v[84:87], v120 offset:9216
    ds_read_b128 v[88:91], v120 offset:10240
    ds_read_b128 v[92:95], v120 offset:11264
    s_waitcnt lgkmcnt(3)
    buffer_store_dwordx4 v[80:83], v121, s[24:27], 0 offen offset:256 nt
    s_waitcnt lgkmcnt(2)
    buffer_store_dwordx4 v[84:87], v122, s[24:27], 0 offen offset:256 nt
    s_waitcnt lgkmcnt(1)
    buffer_store_dwordx4 v[88:91], v123, s[24:27], 0 offen offset:256 nt
    s_waitcnt lgkmcnt(0)
    buffer_store_dwordx4 v[92:95], v124, s[24:27], 0 offen offset:256 nt
    s_endpgm
L_loader:
    s_bitcmp1_b32 s32, 0
    s_cbranch_scc0 L_idle
    s_mov_b32 s20, s6
    s_mov_b32 s21, s7
    s_mov_b32 s22, s33
    s_mov_b32 s24, s8
    s_mov_b32 s25, s9
    s_mov_b32 s26, s33
    s_add_u32 s54, s36, s15
    s_mov_b32 s55, s54
    s_bitcmp1_b32 s32, 2
    s_cselect_b32 s52, 0, 99
    s_bitcmp1_b32 s32, 3
    s_cselect_b32 s53, 0, 99
    s_cmp_ge_u32 s52, s40
    s_cbranch_scc1 L_bl_1
    s_add_u32 s29, s54, 0
    s_add_u32 m0, s37, 0
    s_nop 0
    buffer_load_dwordx4 v5, s[20:23], s29 offen offset:0  lds
    s_add_u32 m0, s37, 3968
    s_nop 0
    buffer_load_dwordx4 v5, s[20:23], s29 offen offset:128  lds
    s_add_u32 m0, s37, 7936
    s_nop 0
    buffer_load_dwordx4 v5, s[20:23], s29 offen offset:256  lds
    s_add_u32 s29, s54, 49152
    s_add_u32 m0, s37, 1024
    s_nop 0
    buffer_load_dwordx4 v6, s[20:23], s29 offen offset:0  lds
    s_add_u32 m0, s37, 4992
    s_nop 0
    buffer_load_dwordx4 v6, s[20:23], s29 offen offset:128  lds
    s_add_u32 m0, s37, 8960
    s_nop 0
    buffer_load_dwordx4 v6, s[20:23], s29 offen offset:256  lds
    s_add_u32 s60, s60, 6
    s_bitcmp1_b32 s32, 6
    s_cbranch_scc0 L_blh_2
    s_add_u32 s29, s54, 98304
    s_add_u32 m0, s37, 2048
    s_nop 0
    buffer_load_dwordx4 v5, s[20:23], s29 offen offset:0  lds
    s_add_u32 m0, s37, 6016
    s_nop 0
    buffer_load_dwordx4 v5, s[20:23], s29 offen offset:128  lds
    s_add_u32 m0, s37, 9984
    s_nop 0
    buffer_load_dwordx4 v5, s[20:23], s29 offen offset:256  lds
    s_add_u32 s29, s54, 147456
    s_add_u32 m0, s37, 3072
    s_nop 0
    buffer_load_dwordx4 v6, s[20:23], s29 offen offset:0  lds
    s_add_u32 m0, s37, 7040
    s_nop 0
    buffer_load_dwordx4 v6, s[20:23], s29 offen offset:128  lds
    s_add_u32 m0, s37, 11008
    s_nop 0
    buffer_load_dwordx4 v6, s[20:23], s29 offen offset:256  lds
    s_add_u32 s60, s60, 6
L_blh_2:
    s_add_u32 s52, s52, 1
    s_add_u32 s54, s54, 196608
    s_add_u32 s37, s37, s38
    s_sub_u32 s30, s37, 147456
    s_cselect_b32 s37, s37, s30
L_bl_1:
    s_mov_b32 s48, 0
    s_mov_b32 s50, 0
    s_mov_b32 s63, 5
    s_mov_b32 s62, 0
    s_mov_b32 s51, -1
L_ld_loop:
L_sa_4:
    s_mov_b32 s60, 0
    s_cmp_ge_u32 s52, s40
    s_cbranch_scc1 L_bl_6
    s_add_u32 s29, s54, 0
    s_add_u32 m0, s37, 0
    s_nop 0
    buffer_load_dwordx4 v5, s[20:23], s29 offen offset:0  lds
    s_add_u32 m0, s37, 3968
    s_nop 0
    buffer_load_dwordx4 v5, s[20:23], s29 offen offset:128  lds
    s_add_u32 m0, s37, 7936
    s_nop 0
    buffer_load_dwordx4 v5, s[20:23], s29 offen offset:256  lds
    s_add_u32 s29, s54, 49152
    s_add_u32 m0, s37, 1024
    s_nop 0
    buffer_load_dwordx4 v6, s[20:23], s29 offen offset:0  lds
    s_add_u32 m0, s37, 4992
    s_nop 0
    buffer_load_dwordx4 v6, s[20:23], s29 offen offset:128  lds
    s_add_u32 m0, s37, 8960
    s_nop 0
    buffer_load_dwordx4 v6, s[20:23], s29 offen offset:256  lds
    s_add_u32 s60, s60, 6
    s_bitcmp1_b32 s32, 6
    s_cbranch_scc0 L_blh_7
    s_add_u32 s29, s54, 98304
    s_add_u32 m0, s37, 2048
    s_nop 0
    buffer_load_dwordx4 v5, s[20:23], s29 offen offset:0  lds
    s_add_u32 m0, s37, 6016
    s_nop 0
    buffer_load_dwordx4 v5, s[20:23], s29 offen offset:128  lds
    s_add_u32 m0, s37, 9984
    s_nop 0
    buffer_load_dwordx4 v5, s[20:23], s29 offen offset:256  lds
    s_add_u32 s29, s54, 147456
    s_add_u32 m0, s37, 3072
    s_nop 0
    buffer_load_dwordx4 v6, s[20:23], s29 offen offset:0  lds
    s_add_u32 m0, s37, 7040
    s_nop 0
    buffer_load_dwordx4 v6, s[20:23], s29 offen offset:128  lds
    s_add_u32 m0, s37, 11008
    s_nop 0
    buffer_load_dwordx4 v6, s[20:23], s29 offen offset:256  lds
    s_add_u32 s60, s60, 6
L_blh_7:
    s_add_u32 s52, s52, 1
    s_add_u32 s54, s54, 196608
    s_add_u32 s37, s37, s38
    s_sub_u32 s30, s37, 147456
    s_cselect_b32 s37, s37, s30
L_bl_6:
    s_cmp_ge_u32 s53, s40
    s_cbranch_scc1 L_bl_8
    s_add_u32 s29, s55, 0
    s_add_u32 m0, s39, 0
    s_nop 0
    buffer_load_dwordx4 v7, s[24:27], s29 offen offset:0  lds
    s_add_u32 m0, s39, 3968
    s_nop 0
    buffer_load_dwordx4 v7, s[24:27], s29 offen offset:128  lds
    s_add_u32 m0, s39, 7936
    s_nop 0
    buffer_load_dwordx4 v7, s[24:27], s29 offen offset:256  lds
    s_add_u32 s29, s55, 49152
    s_add_u32 m0, s39, 1024
    s_nop 0
    buffer_load_dwordx4 v7, s[24:27], s29 offen offset:0  lds
    s_add_u32 m0, s39, 4992
    s_nop 0
    buffer_load_dwordx4 v7, s[24:27], s29 offen offset:128  lds
    s_add_u32 m0, s39, 8960
    s_nop 0
    buffer_load_dwordx4 v7, s[24:27], s29 offen offset:256  lds
    s_add_u32 s60, s60, 6
    s_bitcmp1_b32 s32, 6
    s_cbranch_scc0 L_blh_9
    s_add_u32 s29, s55, 98304
    s_add_u32 m0, s39, 2048
    s_nop 0
    buffer_load_dwordx4 v7, s[24:27], s29 offen offset:0  lds
    s_add_u32 m0, s39, 6016
    s_nop 0
    buffer_load_dwordx4 v7, s[24:27], s29 offen offset:128  lds
    s_add_u32 m0, s39, 9984
    s_nop 0
    buffer_load_dwordx4 v7, s[24:27], s29 offen offset:256  lds
    s_add_u32 s29, s55, 147456
    s_add_u32 m0, s39, 3072
    s_nop 0
    buffer_load_dwordx4 v7, s[24:27], s29 offen offset:0  lds
    s_add_u32 m0, s39, 7040
    s_nop 0
    buffer_load_dwordx4 v7, s[24:27], s29 offen offset:128  lds
    s_add_u32 m0, s39, 11008
    s_nop 0
    buffer_load_dwordx4 v7, s[24:27], s29 offen offset:256  lds
    s_add_u32 s60, s60, 6
L_blh_9:
    s_add_u32 s53, s53, 1
    s_add_u32 s55, s55, 196608
    s_add_u32 s39, s39, s38
    s_sub_u32 s30, s39, 147456
    s_cselect_b32 s39, s39, s30
L_bl_8:
    s_add_u32 s48, s48, s60
    s_lshl_b32 s60, s60, s63
    s_or_b32 s50, s50, s60
    s_add_u32 s63, s63, 5
    s_cmp_eq_u32 s62, 0
    s_cbranch_scc1 L_sn_5
    s_mov_b32 s62, 0
    s_sub_u32 s47, s47, 1
    s_branch L_sa_4
L_sn_5:
    s_and_b32 s60, s50, 31
    s_sub_u32 s48, s48, s60
    s_lshr_b32 s50, s50, 5
    s_sub_u32 s63, s63, 5
    s_waitcnt vmcnt(48)
    s_cmp_ge_u32 s48, 48
    s_cbranch_scc1 L_sw_3
    s_waitcnt vmcnt(36)
    s_cmp_ge_u32 s48, 36
    s_cbranch_scc1 L_sw_3
    s_waitcnt vmcnt(24)
    s_cmp_ge_u32 s48, 24
    s_cbranch_scc1 L_sw_3
    s_waitcnt vmcnt(18)
    s_cmp_ge_u32 s48, 18
    s_cbranch_scc1 L_sw_3
    s_waitcnt vmcnt(12)
    s_cmp_ge_u32 s48, 12
    s_cbranch_scc1 L_sw_3
    s_waitcnt vmcnt(6)
    s_cmp_ge_u32 s48, 6
    s_cbranch_scc1 L_sw_3
    s_waitcnt vmcnt(0)
L_sw_3:
    s_min_u32 s62, s47, 1
    s_barrier
    s_add_u32 s51, s51, 1
    s_cmp_lt_u32 s51, s40
    s_cbranch_scc1 L_ld_loop
L_end:
    s_endpgm
L_idle:
    s_add_u32 s51, s40, 1
L_idle_loop:
    s_barrier
    s_sub_u32 s51, s51, 1
    s_cmp_lg_u32 s51, 0
    s_cbranch_scc1 L_idle_loop
    s_endpgm
L_pref:
    s_waitcnt vmcnt(0)
    s_cmp_eq_u32 s48, -1
    s_cbranch_scc1 L_pfs_10
    s_bitcmp1_b32 s48, 31
    s_cselect_b32 s20, s8, s6
    s_cselect_b32 s21, s9, s7
    s_bitcmp1_b32 s48, 30
    s_cselect_b32 s20, s4, s20
    s_cselect_b32 s21, s5, s21
    s_and_b32 s30, s48, 0xffffff
    s_add_u32 s30, s30, s15
    buffer_load_dword v19, v8, s[20:23], s30 offen
    s_waitcnt vmcnt(0)
L_pfs_10:
    s_cmp_eq_u32 s49, -1
    s_cbranch_scc1 L_pfs_11
    s_bitcmp1_b32 s49, 31
    s_cselect_b32 s20, s8, s6
    s_cselect_b32 s21, s9, s7
    s_bitcmp1_b32 s49, 30
    s_cselect_b32 s20, s4, s20
    s_cselect_b32 s21, s5, s21
    s_and_b32 s30, s49, 0xffffff
    s_add_u32 s30, s30, s15
    buffer_load_dword v19, v8, s[20:23], s30 offen
    s_waitcnt vmcnt(0)
L_pfs_11:
    s_cmp_eq_u32 s50, -1
    s_cbranch_scc1 L_pfs_12
    s_bitcmp1_b32 s50, 31
    s_cselect_b32 s20, s8, s6
    s_cselect_b32 s21, s9, s7
    s_bitcmp1_b32 s50, 30
    s_cselect_b32 s20, s4, s20
    s_cselect_b32 s21, s5, s21
    s_and_b32 s30, s50, 0xffffff
    s_add_u32 s30, s30, s15
    buffer_load_dword v19, v8, s[20:23], s30 offen
    s_waitcnt vmcnt(0)
L_pfs_12:
    s_cmp_eq_u32 s51, -1
    s_cbranch_scc1 L_pfs_13
    s_bitcmp1_b32 s51, 31
    s_cselect_b32 s20, s8, s6
    s_cselect_b32 s21, s9, s7
    s_bitcmp1_b32 s51, 30
    s_cselect_b32 s20, s4, s20
    s_cselect_b32 s21, s5, s21
    s_and_b32 s30, s51, 0xffffff
    s_add_u32 s30, s30, s15
    buffer_load_dword v19, v8, s[20:23], s30 offen
    s_waitcnt vmcnt(0)
L_pfs_13:
    s_cmp_eq_u32 s52, -1
    s_cbranch_scc1 L_pfs_14
    s_bitcmp1_b32 s52, 31
    s_cselect_b32 s20, s8, s6
    s_cselect_b32 s21, s9, s7
    s_bitcmp1_b32 s52, 30
    s_cselect_b32 s20, s4, s20
    s_cselect_b32 s21, s5, s21
    s_and_b32 s30, s52, 0xffffff
    s_add_u32 s30, s30, s15
    buffer_load_dword v19, v8, s[20:23], s30 offen
    s_waitcnt vmcnt(0)
L_pfs_14:
    s_cmp_eq_u32 s53, -1
    s_cbranch_scc1 L_pfs_15
    s_bitcmp1_b32 s53, 31
    s_cselect_b32 s20, s8, s6
    s_cselect_b32 s21, s9, s7
    s_bitcmp1_b32 s53, 30
    s_cselect_b32 s20, s4, s20
    s_cselect_b32 s21, s5, s21
    s_and_b32 s30, s53, 0xffffff
    s_add_u32 s30, s30, s15
    buffer_load_dword v19, v8, s[20:23], s30 offen
    s_waitcnt vmcnt(0)
L_pfs_15:
    s_cmp_eq_u32 s54, -1
    s_cbranch_scc1 L_pfs_16
    s_bitcmp1_b32 s54, 31
    s_cselect_b32 s20, s8, s6
    s_cselect_b32 s21, s9, s7
    s_bitcmp1_b32 s54, 30
    s_cselect_b32 s20, s4, s20
    s_cselect_b32 s21, s5, s21
    s_and_b32 s30, s54, 0xffffff
    s_add_u32 s30, s30, s15
    buffer_load_dword v19, v8, s[20:23], s30 offen
    s_waitcnt vmcnt(0)
L_pfs_16:
    s_cmp_eq_u32 s55, -1
    s_cbranch_scc1 L_pfs_17
    s_bitcmp1_b32 s55, 31
    s_cselect_b32 s20, s8, s6
    s_cselect_b32 s21, s9, s7
    s_bitcmp1_b32 s55, 30
    s_cselect_b32 s20, s4, s20
    s_cselect_b32 s21, s5, s21
    s_and_b32 s30, s55, 0xffffff
    s_add_u32 s30, s30, s15
    buffer_load_dword v19, v8, s[20:23], s30 offen
    s_waitcnt vmcnt(0)
L_pfs_17:
    s_barrier
    s_branch L_pref_done
L_solo:
    s_cmp_lg_u32 s61, 0
    s_cbranch_scc1 L_epi2
    s_mov_b32 s61, 1
    s_nop 15
    v_lshrrev_b32 v1, 3, v0
    v_and_b32 v2, 7, v0
    v_bfe_u32 v3, v0, 4, 2
    v_bfe_u32 v4, v0, 4, 1
    v_mul_u32_u24 v1, 6144, v1
    v_xor_b32 v3, v2, v3
    v_lshlrev_b32 v4, 2, v4
    v_xor_b32 v4, v2, v4
    v_lshl_add_u32 v5, v3, 4, v1
    v_lshl_add_u32 v7, v4, 4, v1
    v_xor_b32 v6, 64, v5
    v_mov_b32 v77, v5
    v_mov_b32 v78, v6
    v_mov_b32 v79, v7
    s_add_u32 s29, s34, 0
    s_add_u32 m0, s90, 0
    s_nop 0
    buffer_load_dwordx4 v5, s[16:19], s29 offen offset:0  lds
    s_add_u32 m0, s90, 3968
    s_nop 0
    buffer_load_dwordx4 v5, s[16:19], s29 offen offset:128  lds
    s_add_u32 m0, s90, 7936
    s_nop 0
    buffer_load_dwordx4 v5, s[16:19], s29 offen offset:256  lds
    s_add_u32 s29, s34, 49152
    s_add_u32 m0, s90, 1024
    s_nop 0
    buffer_load_dwordx4 v6, s[16:19], s29 offen offset:0  lds
    s_add_u32 m0, s90, 4992
    s_nop 0
    buffer_load_dwordx4 v6, s[16:19], s29 offen offset:128  lds
    s_add_u32 m0, s90, 8960
    s_nop 0
    buffer_load_dwordx4 v6, s[16:19], s29 offen offset:256  lds
    s_add_u32 s29, s34, 98304
    s_add_u32 m0, s90, 2048
    s_nop 0
    buffer_load_dwordx4 v5, s[16:19], s29 offen offset:0  lds
    s_add_u32 m0, s90, 6016
    s_nop 0
    buffer_load_dwordx4 v5, s[16:19], s29 offen offset:128  lds
    s_add_u32 m0, s90, 9984
    s_nop 0
    buffer_load_dwordx4 v5, s[16:19], s29 offen offset:256  lds
    s_add_u32 s29, s34, 147456
    s_add_u32 m0, s90, 3072
    s_nop 0
    buffer_load_dwordx4 v6, s[16:19], s29 offen offset:0  lds
    s_add_u32 m0, s90, 7040
    s_nop 0
    buffer_load_dwordx4 v6, s[16:19], s29 offen offset:128  lds
    s_add_u32 m0, s90, 11008
    s_nop 0
    buffer_load_dwordx4 v6, s[16:19], s29 offen offset:256  lds
    v_add_u32 v11, s90, v9
    v_xor_b32 v12, 32, v11
    v_xor_b32 v13, 64, v11
    v_xor_b32 v14, 96, v11
    v_add_u32 v15, s90, v10
    v_xor_b32 v16, 64, v15
    v_mov_b32 v160, 0
    v_mov_b32 v161, 0
    v_mov_b32 v162, 0
    v_mov_b32 v163, 0
    v_mov_b32 v164, 0
    v_mov_b32 v165, 0
    v_mov_b32 v166, 0
    v_mov_b32 v167, 0
    v_mov_b32 v168, 0
    v_mov_b32 v169, 0
    v_mov_b32 v170, 0
    v_mov_b32 v171, 0
    v_mov_b32 v172, 0
    v_mov_b32 v173, 0
    v_mov_b32 v174, 0
    v_mov_b32 v175, 0
    v_mov_b32 v176, 0
    v_mov_b32 v177, 0
    v_mov_b32 v178, 0
    v_mov_b32 v179, 0
    v_mov_b32 v180, 0
    v_mov_b32 v181, 0
    v_mov_b32 v182, 0
    v_mov_b32 v183, 0
    v_mov_b32 v184, 0
    v_mov_b32 v185, 0
    v_mov_b32 v186, 0
    v_mov_b32 v187, 0
    v_mov_b32 v188, 0
    v_mov_b32 v189, 0
    v_mov_b32 v190, 0
    v_mov_b32 v191, 0
    v_mov_b32 v192, 0
    v_mov_b32 v193, 0
    v_mov_b32 v194, 0
    v_mov_b32 v195, 0
    v_mov_b32 v196, 0
    v_mov_b32 v197, 0
    v_mov_b32 v198, 0
    v_mov_b32 v199, 0
    v_mov_b32 v200, 0
    v_mov_b32 v201, 0
    v_mov_b32 v202, 0
    v_mov_b32 v203, 0
    v_mov_b32 v204, 0
    v_mov_b32 v205, 0
    v_mov_b32 v206, 0
    v_mov_b32 v207, 0
    v_mov_b32 v208, 0
    v_mov_b32 v209, 0
    v_mov_b32 v210, 0
    v_mov_b32 v211, 0
    v_mov_b32 v212, 0
    v_mov_b32 v213, 0
    v_mov_b32 v214, 0
    v_mov_b32 v215, 0
    v_mov_b32 v216, 0
    v_mov_b32 v217, 0
    v_mov_b32 v218, 0
    v_mov_b32 v219, 0
    v_mov_b32 v220, 0
    v_mov_b32 v221, 0
    v_mov_b32 v222, 0
    v_mov_b32 v223, 0
    v_mov_b32 v224, 0
    v_mov_b32 v225, 0
    v_mov_b32 v226, 0
    v_mov_b32 v227, 0
    v_mov_b32 v228, 0
    v_mov_b32 v229, 0
    v_mov_b32 v230, 0
    v_mov_b32 v231, 0
    v_mov_b32 v232, 0
    v_mov_b32 v233, 0
    v_mov_b32 v234, 0
    v_mov_b32 v235, 0
    v_mov_b32 v236, 0
    v_mov_b32 v237, 0
    v_mov_b32 v238, 0
    v_mov_b32 v239, 0
    v_mov_b32 v240, 0
    v_mov_b32 v241, 0
    v_mov_b32 v242, 0
    v_mov_b32 v243, 0
    v_mov_b32 v244, 0
    v_mov_b32 v245, 0
    v_mov_b32 v246, 0
    v_mov_b32 v247, 0
    v_mov_b32 v248, 0
    v_mov_b32 v249, 0
    v_mov_b32 v250, 0
    v_mov_b32 v251, 0
    v_mov_b32 v252, 0
    v_mov_b32 v253, 0
    v_mov_b32 v254, 0
    v_mov_b32 v255, 0
    v_mov_b32 v20, 0
    v_mov_b32 v22, 0
    v_mov_b32 v21, 0xff800000
    s_waitcnt vmcnt(0)
    ds_read_b128 v[112:115], v11 offset:0
    ds_read_b128 v[116:119], v12 offset:0
    ds_read_b128 v[120:123], v13 offset:0
    ds_read_b128 v[124:127], v14 offset:0
    ds_read_b128 v[128:131], v11 offset:4096
    ds_read_b128 v[132:135], v12 offset:4096
    ds_read_b128 v[136:139], v13 offset:4096
    ds_read_b128 v[140:143], v14 offset:4096
    ds_read_b128 v[144:147], v11 offset:8192
    ds_read_b128 v[148:151], v12 offset:8192
    ds_read_b128 v[152:155], v13 offset:8192
    ds_read_b128 v[156:159], v14 offset:8192
    s_waitcnt lgkmcnt(0)
    s_mov_b32 s51, 0
    s_add_u32 s36, s45, s15
    s_mov_b32 s46, 0
    v_mov_b32 v96, v5
    v_mov_b32 v97, v6
    v_mov_b32 v98, v7
L_solo_loop:
    v_mov_b32 v5, v96
    v_mov_b32 v6, v97
    s_mov_b32 s20, s6
    s_mov_b32 s21, s7
    s_add_u32 s29, s36, 0
    s_add_u32 m0, s90, 0
    s_nop 0
    buffer_load_dwordx4 v5, s[20:23], s29 offen offset:0  lds
    s_add_u32 m0, s90, 3968
    s_nop 0
    buffer_load_dwordx4 v5, s[20:23], s29 offen offset:128  lds
    s_add_u32 m0, s90, 7936
    s_nop 0
    buffer_load_dwordx4 v5, s[20:23], s29 offen offset:256  lds
    s_add_u32 s29, s36, 49152
    s_add_u32 m0, s90, 1024
    s_nop 0
    buffer_load_dwordx4 v6, s[20:23], s29 offen offset:0  lds
    s_add_u32 m0, s90, 4992
    s_nop 0
    buffer_load_dwordx4 v6, s[20:23], s29 offen offset:128  lds
    s_add_u32 m0, s90, 8960
    s_nop 0
    buffer_load_dwordx4 v6, s[20:23], s29 offen offset:256  lds
    s_add_u32 s29, s36, 98304
    s_add_u32 m0, s90, 2048
    s_nop 0
    buffer_load_dwordx4 v5, s[20:23], s29 offen offset:0  lds
    s_add_u32 m0, s90, 6016
    s_nop 0
    buffer_load_dwordx4 v5, s[20:23], s29 offen offset:128  lds
    s_add_u32 m0, s90, 9984
    s_nop 0
    buffer_load_dwordx4 v5, s[20:23], s29 offen offset:256  lds
    s_add_u32 s29, s36, 147456
    s_add_u32 m0, s90, 3072
    s_nop 0
    buffer_load_dwordx4 v6, s[20:23], s29 offen offset:0  lds
    s_add_u32 m0, s90, 7040
    s_nop 0
    buffer_load_dwordx4 v6, s[20:23], s29 offen offset:128  lds
    s_add_u32 m0, s90, 11008
    s_nop 0
    buffer_load_dwordx4 v6, s[20:23], s29 offen offset:256  lds
    s_waitcnt vmcnt(0)
    ds_read_b128 v[24:27], v11 offset:0
    ds_read_b128 v[28:31], v12 offset:0
    ds_read_b128 v[32:35], v13 offset:0
    ds_read_b128 v[36:39], v14 offset:0
    ds_read_b128 v[40:43], v11 offset:4096
    ds_read_b128 v[44:47], v12 offset:4096
    ds_read_b128 v[48:51], v13 offset:4096
    ds_read_b128 v[52:55], v14 offset:4096
    ds_read_b128 v[56:59], v11 offset:8192
    ds_read_b128 v[60:63], v12 offset:8192
    ds_read_b128 v[64:67], v13 offset:8192
    ds_read_b128 v[68:71], v14 offset:8192
    s_waitcnt lgkmcnt(11)
    v_mfma_f32_32x32x16_bf16 v[80:95], v[24:27], v[112:115], 0
    s_waitcnt lgkmcnt(10)
    v_mfma_f32_32x32x16_bf16 v[80:95], v[28:31], v[116:119], v[80:95]
    s_waitcnt lgkmcnt(9)
    v_mfma_f32_32x32x16_bf16 v[80:95], v[32:35], v[120:123], v[80:95]
    s_waitcnt lgkmcnt(8)
    v_mfma_f32_32x32x16_bf16 v[80:95], v[36:39], v[124:127], v[80:95]
    s_waitcnt lgkmcnt(7)
    v_mfma_f32_32x32x16_bf16 v[80:95], v[40:43], v[128:131], v[80:95]
    s_waitcnt lgkmcnt(6)
    v_mfma_f32_32x32x16_bf16 v[80:95], v[44:47], v[132:135], v[80:95]
    s_waitcnt lgkmcnt(5)
    v_mfma_f32_32x32x16_bf16 v[80:95], v[48:51], v[136:139], v[80:95]
    s_waitcnt lgkmcnt(4)
    v_mfma_f32_32x32x16_bf16 v[80:95], v[52:55], v[140:143], v[80:95]
    s_waitcnt lgkmcnt(3)
    v_mfma_f32_32x32x16_bf16 v[80:95], v[56:59], v[144:147], v[80:95]
    s_waitcnt lgkmcnt(2)
    v_mfma_f32_32x32x16_bf16 v[80:95], v[60:63], v[148:151], v[80:95]
    s_waitcnt lgkmcnt(1)
    v_mfma_f32_32x32x16_bf16 v[80:95], v[64:67], v[152:155], v[80:95]
    s_waitcnt lgkmcnt(0)
    v_mfma_f32_32x32x16_bf16 v[80:95], v[68:71], v[156:159], v[80:95]
    v_mov_b32 v7, v98
    s_mov_b32 s20, s8
    s_mov_b32 s21, s9
    s_add_u32 s29, s36, 0
    s_add_u32 m0, s90, 0
    s_nop 0
    buffer_load_dwordx4 v7, s[20:23], s29 offen offset:0  lds
    s_add_u32 m0, s90, 3968
    s_nop 0
    buffer_load_dwordx4 v7, s[20:23], s29 offen offset:128  lds
    s_add_u32 m0, s90, 7936
    s_nop 0
    buffer_load_dwordx4 v7, s[20:23], s29 offen offset:256  lds
    s_add_u32 s29, s36, 49152
    s_add_u32 m0, s90, 1024
    s_nop 0
    buffer_load_dwordx4 v7, s[20:23], s29 offen offset:0  lds
    s_add_u32 m0, s90, 4992
    s_nop 0
    buffer_load_dwordx4 v7, s[20:23], s29 offen offset:128  lds
    s_add_u32 m0, s90, 8960
    s_nop 0
    buffer_load_dwordx4 v7, s[20:23], s29 offen offset:256  lds
    s_add_u32 s29, s36, 98304
    s_add_u32 m0, s90, 2048
    s_nop 0
    buffer_load_dwordx4 v7, s[20:23], s29 offen offset:0  lds
    s_add_u32 m0, s90, 6016
    s_nop 0
    buffer_load_dwordx4 v7, s[20:23], s29 offen offset:128  lds
    s_add_u32 m0, s90, 9984
    s_nop 0
    buffer_load_dwordx4 v7, s[20:23], s29 offen offset:256  lds
    s_add_u32 s29, s36, 147456
    s_add_u32 m0, s90, 3072
    s_nop 0
    buffer_load_dwordx4 v7, s[20:23], s29 offen offset:0  lds
    s_add_u32 m0, s90, 7040
    s_nop 0
    buffer_load_dwordx4 v7, s[20:23], s29 offen offset:128  lds
    s_add_u32 m0, s90, 11008
    s_nop 0
    buffer_load_dwordx4 v7, s[20:23], s29 offen offset:256  lds
    s_cmp_lg_u32 s51, s49
    s_cbranch_scc1 L_solo_nm
    v_lshrrev_b32 v17, 5, v0
    v_lshlrev_b32 v17, 2, v17
    v_mov_b32 v18, 0xff800000
    s_sub_u32 s30, s44, 0
    v_cmp_gt_i32 vcc, s30, v17
    s_nop 1
    v_cndmask_b32 v80, v18, v80, vcc
    s_sub_u32 s30, s44, 1
    v_cmp_gt_i32 vcc, s30, v17
    s_nop 1
    v_cndmask_b32 v81, v18, v81, vcc
    s_sub_u32 s30, s44, 2
    v_cmp_gt_i32 vcc, s30, v17
    s_nop 1
    v_cndmask_b32 v82, v18, v82, vcc
    s_sub_u32 s30, s44, 3
    v_cmp_gt_i32 vcc, s30, v17
    s_nop 1
    v_cndmask_b32 v83, v18, v83, vcc
    s_sub_u32 s30, s44, 8
    v_cmp_gt_i32 vcc, s30, v17
    s_nop 1
    v_cndmask_b32 v84, v18, v84, vcc
    s_sub_u32 s30, s44, 9
    v_cmp_gt_i32 vcc, s30, v17
    s_nop 1
    v_cndmask_b32 v85, v18, v85, vcc
    s_sub_u32 s30, s44, 10
    v_cmp_gt_i32 vcc, s30, v17
    s_nop 1
    v_cndmask_b32 v86, v18, v86, vcc
    s_sub_u32 s30, s44, 11
    v_cmp_gt_i32 vcc, s30, v17
    s_nop 1
    v_cndmask_b32 v87, v18, v87, vcc
    s_sub_u32 s30, s44, 16
    v_cmp_gt_i32 vcc, s30, v17
    s_nop 1
    v_cndmask_b32 v88, v18, v88, vcc
    s_sub_u32 s30, s44, 17
    v_cmp_gt_i32 vcc, s30, v17
    s_nop 1
    v_cndmask_b32 v89, v18, v89, vcc
    s_sub_u32 s30, s44, 18
    v_cmp_gt_i32 vcc, s30, v17
    s_nop 1
    v_cndmask_b32 v90, v18, v90, vcc
    s_sub_u32 s30, s44, 19
    v_cmp_gt_i32 vcc, s30, v17
    s_nop 1
    v_cndmask_b32 v91, v18, v91, vcc
    s_sub_u32 s30, s44, 24
    v_cmp_gt_i32 vcc, s30, v17
    s_nop 1
    v_cndmask_b32 v92, v18, v92, vcc
    s_sub_u32 s30, s44, 25
    v_cmp_gt_i32 vcc, s30, v17
    s_nop 1
    v_cndmask_b32 v93, v18, v93, vcc
    s_sub_u32 s30, s44, 26
    v_cmp_gt_i32 vcc, s30, v17
    s_nop 1
    v_cndmask_b32 v94, v18, v94, vcc
    s_sub_u32 s30, s44, 27
    v_cmp_gt_i32 vcc, s30, v17
    s_nop 1
    v_cndmask_b32 v95, v18, v95, vcc
L_solo_nm:
    v_max3_f32 v1, v80, v81, v82
    v_max3_f32 v2, v83, v84, v85
    v_max3_f32 v1, v1, v86, v87
    v_max3_f32 v2, v2, v88, v89
    v_max3_f32 v1, v1, v90, v91
    v_max3_f32 v2, v2, v92, v93
    v_max3_f32 v1, v1, v94, v95
    v_max_f32 v1, v1, v2
    v_mov_b32 v2, v1
    s_nop 1
    v_permlane32_swap_b32 v2, v1
    s_nop 0
    v_max_f32 v1, v1, v2
    v_max_f32 v1, v1, v21
    v_sub_f32 v2, v21, v1
    v_mul_f32 v2, s56, v2
    v_exp_f32 v2, v2
    v_mov_b32 v21, v1
    v_mul_f32 v23, s56, v1
    v_sub_f32 v23, 0, v23
    v_mul_f32 v20, v20, v2
    v_mul_f32 v160, v160, v2
    v_mul_f32 v161, v161, v2
    v_mul_f32 v162, v162, v2
    v_mul_f32 v163, v163, v2
    v_mul_f32 v164, v164, v2
    v_mul_f32 v165, v165, v2
    v_mul_f32 v166, v166, v2
    v_mul_f32 v167, v167, v2
    v_mul_f32 v168, v168, v2
    v_mul_f32 v169, v169, v2
    v_mul_f32 v170, v170, v2
    v_mul_f32 v171, v171, v2
    v_mul_f32 v172, v172, v2
    v_mul_f32 v173, v173, v2
    v_mul_f32 v174, v174, v2
    v_mul_f32 v175, v175, v2
    v_mul_f32 v176, v176, v2
    v_mul_f32 v177, v177, v2
    v_mul_f32 v178, v178, v2
    v_mul_f32 v179, v179, v2
    v_mul_f32 v180, v180, v2
    v_mul_f32 v181, v181, v2
    v_mul_f32 v182, v182, v2
    v_mul_f32 v183, v183, v2
    v_mul_f32 v184, v184, v2
    v_mul_f32 v185, v185, v2
    v_mul_f32 v186, v186, v2
    v_mul_f32 v187, v187, v2
    v_mul_f32 v188, v188, v2
    v_mul_f32 v189, v189, v2
    v_mul_f32 v190, v190, v2
    v_mul_f32 v191, v191, v2
    v_mul_f32 v192, v192, v2
    v_mul_f32 v193, v193, v2
    v_mul_f32 v194, v194, v2
    v_mul_f32 v195, v195, v2
    v_mul_f32 v196, v196, v2
    v_mul_f32 v197, v197, v2
    v_mul_f32 v198, v198, v2
    v_mul_f32 v199, v199, v2
    v_mul_f32 v200, v200, v2
    v_mul_f32 v201, v201, v2
    v_mul_f32 v202, v202, v2
    v_mul_f32 v203, v203, v2
    v_mul_f32 v204, v204, v2
    v_mul_f32 v205, v205, v2
    v_mul_f32 v206, v206, v2
    v_mul_f32 v207, v207, v2
    v_mul_f32 v208, v208, v2
    v_mul_f32 v209, v209, v2
    v_mul_f32 v210, v210, v2
    v_mul_f32 v211, v211, v2
    v_mul_f32 v212, v212, v2
    v_mul_f32 v213, v213, v2
    v_mul_f32 v214, v214, v2
    v_mul_f32 v215, v215, v2
    v_mul_f32 v216, v216, v2
    v_mul_f32 v217, v217, v2
    v_mul_f32 v218, v218, v2
    v_mul_f32 v219, v219, v2
    v_mul_f32 v220, v220, v2
    v_mul_f32 v221, v221, v2
    v_mul_f32 v222, v222, v2
    v_mul_f32 v223, v223, v2
    v_mul_f32 v224, v224, v2
    v_mul_f32 v225, v225, v2
    v_mul_f32 v226, v226, v2
    v_mul_f32 v227, v227, v2
    v_mul_f32 v228, v228, v2
    v_mul_f32 v229, v229, v2
    v_mul_f32 v230, v230, v2
    v_mul_f32 v231, v231, v2
    v_mul_f32 v232, v232, v2
    v_mul_f32 v233, v233, v2
    v_mul_f32 v234, v234, v2
    v_mul_f32 v235, v235, v2
    v_mul_f32 v236, v236, v2
    v_mul_f32 v237, v237, v2
    v_mul_f32 v238, v238, v2
    v_mul_f32 v239, v239, v2
    v_mul_f32 v240, v240, v2
    v_mul_f32 v241, v241, v2
    v_mul_f32 v242, v242, v2
    v_mul_f32 v243, v243, v2
    v_mul_f32 v244, v244, v2
    v_mul_f32 v245, v245, v2
    v_mul_f32 v246, v246, v2
    v_mul_f32 v247, v247, v2
    v_mul_f32 v248, v248, v2
    v_mul_f32 v249, v249, v2
    v_mul_f32 v250, v250, v2
    v_mul_f32 v251, v251, v2
    v_mul_f32 v252, v252, v2
    v_mul_f32 v253, v253, v2
    v_mul_f32 v254, v254, v2
    v_mul_f32 v255, v255, v2
    v_fma_f32 v1, v80, s56, v23
    v_fma_f32 v2, v81, s56, v23
    v_fma_f32 v3, v82, s56, v23
    v_fma_f32 v4, v83, s56, v23
    v_fma_f32 v5, v84, s56, v23
    v_fma_f32 v6, v85, s56, v23
    v_fma_f32 v7, v86, s56, v23
    v_fma_f32 v8, v87, s56, v23
    v_exp_f32 v1, v1
    v_exp_f32 v2, v2
    v_exp_f32 v3, v3
    v_exp_f32 v4, v4
    v_exp_f32 v5, v5
    v_exp_f32 v6, v6
    v_exp_f32 v7, v7
    v_exp_f32 v8, v8
    s_nop 0
    v_cvt_pk_bf16_f32 v72, v1, v2
    v_cvt_pk_bf16_f32 v73, v3, v4
    v_cvt_pk_bf16_f32 v74, v5, v6
    v_cvt_pk_bf16_f32 v75, v7, v8
    v_add_f32 v20, v20, v1
    v_add_f32 v20, v20, v2
    v_add_f32 v20, v20, v3
    v_add_f32 v20, v20, v4
    v_add_f32 v20, v20, v5
    v_add_f32 v20, v20, v6
    v_add_f32 v20, v20, v7
    v_add_f32 v20, v20, v8
    v_fma_f32 v1, v88, s56, v23
    v_fma_f32 v2, v89, s56, v23
    v_fma_f32 v3, v90, s56, v23
    v_fma_f32 v4, v91, s56, v23
    v_fma_f32 v5, v92, s56, v23
    v_fma_f32 v6, v93, s56, v23
    v_fma_f32 v7, v94, s56, v23
    v_fma_f32 v8, v95, s56, v23
    v_exp_f32 v1, v1
    v_exp_f32 v2, v2
    v_exp_f32 v3, v3
    v_exp_f32 v4, v4
    v_exp_f32 v5, v5
    v_exp_f32 v6, v6
    v_exp_f32 v7, v7
    v_exp_f32 v8, v8
    s_nop 0
    v_cvt_pk_bf16_f32 v76, v1, v2
    v_cvt_pk_bf16_f32 v77, v3, v4
    v_cvt_pk_bf16_f32 v78, v5, v6
    v_cvt_pk_bf16_f32 v79, v7, v8
    v_add_f32 v20, v20, v1
    v_add_f32 v20, v20, v2
    v_add_f32 v20, v20, v3
    v_add_f32 v20, v20, v4
    v_add_f32 v20, v20, v5
    v_add_f32 v20, v20, v6
    v_add_f32 v20, v20, v7
    v_add_f32 v20, v20, v8
    s_waitcnt vmcnt(0)
    ds_read_b64_tr_b16 v[24:25], v15 offset:0
    ds_read_b64_tr_b16 v[26:27], v15 offset:1024
    ds_read_b64_tr_b16 v[28:29], v16 offset:0
    ds_read_b64_tr_b16 v[30:31], v16 offset:1024
    ds_read_b64_tr_b16 v[32:33], v15 offset:4096
    ds_read_b64_tr_b16 v[34:35], v15 offset:5120
    ds_read_b64_tr_b16 v[36:37], v16 offset:4096
    ds_read_b64_tr_b16 v[38:39], v16 offset:5120
    ds_read_b64_tr_b16 v[40:41], v15 offset:8192
    ds_read_b64_tr_b16 v[42:43], v15 offset:9216
    ds_read_b64_tr_b16 v[44:45], v16 offset:8192
    ds_read_b64_tr_b16 v[46:47], v16 offset:9216
    ds_read_b64_tr_b16 v[48:49], v15 offset:2048
    ds_read_b64_tr_b16 v[50:51], v15 offset:3072
    ds_read_b64_tr_b16 v[52:53], v16 offset:2048
    ds_read_b64_tr_b16 v[54:55], v16 offset:3072
    ds_read_b64_tr_b16 v[56:57], v15 offset:6144
    ds_read_b64_tr_b16 v[58:59], v15 offset:7168
    ds_read_b64_tr_b16 v[60:61], v16 offset:6144
    ds_read_b64_tr_b16 v[62:63], v16 offset:7168
    ds_read_b64_tr_b16 v[64:65], v15 offset:10240
    ds_read_b64_tr_b16 v[66:67], v15 offset:11264
    ds_read_b64_tr_b16 v[68:69], v16 offset:10240
    ds_read_b64_tr_b16 v[70:71], v16 offset:11264
    s_waitcnt lgkmcnt(0)
    v_mfma_f32_32x32x16_bf16 v[160:175], v[24:27], v[72:75], v[160:175]
    v_mfma_f32_32x32x16_bf16 v[176:191], v[28:31], v[72:75], v[176:191]
    v_mfma_f32_32x32x16_bf16 v[192:207], v[32:35], v[72:75], v[192:207]
    v_mfma_f32_32x32x16_bf16 v[208:223], v[36:39], v[72:75], v[208:223]
    v_mfma_f32_32x32x16_bf16 v[224:239], v[40:43], v[72:75], v[224:239]
    v_mfma_f32_32x32x16_bf16 v[240:255], v[44:47], v[72:75], v[240:255]
    v_mfma_f32_32x32x16_bf16 v[160:175], v[48:51], v[76:79], v[160:175]
    v_mfma_f32_32x32x16_bf16 v[176:191], v[52:55], v[76:79], v[176:191]
    v_mfma_f32_32x32x16_bf16 v[192:207], v[56:59], v[76:79], v[192:207]
    v_mfma_f32_32x32x16_bf16 v[208:223], v[60:63], v[76:79], v[208:223]
    v_mfma_f32_32x32x16_bf16 v[224:239], v[64:67], v[76:79], v[224:239]
    v_mfma_f32_32x32x16_bf16 v[240:255], v[68:71], v[76:79], v[240:255]
    s_add_u32 s36, s36, 196608
    s_add_u32 s51, s51, 1
    s_cmp_lt_u32 s51, s40
    s_cbranch_scc1 L_solo_loop
    v_min_f32 v23, 0, v23
    v_add_f32 v20, v20, v22
    s_add_u32 s90, s41, s43
    v_exp_f32 v6, v23
    v_mov_b32 v1, v20
    s_sub_u32 s30, s90, 147456
    s_cselect_b32 s90, s90, s30
    v_and_b32 v2, 31, v0
    v_permlane32_swap_b32 v1, v20
    v_lshrrev_b32 v3, 5, v0
    v_add_f32 v20, v20, v1
    v_mul_f32 v6, s46, v6
    v_lshlrev_b32 v4, 7, v2
    v_and_b32 v2, 7, v2
    v_fma_f32 v7, v6, s47, v20
    v_add_f32 v20, v20, v6
    v_lshl_add_u32 v4, v2, 4, v4
    v_cmp_nge_f32 vcc, s57, v7
    v_rcp_f32 v20, v20
    v_lshl_add_u32 v4, v3, 3, v4
    v_add_u32 v112, s90, v4
    v_mov_b32 v21, v20
    v_xor_b32 v113, 16, v112
    v_xor_b32 v114, 32, v112
    v_xor_b32 v115, 48, v112
    v_xor_b32 v116, 64, v112
    v_xor_b32 v117, 80, v112
    v_xor_b32 v118, 96, v112
    v_xor_b32 v119, 112, v112
    v_lshlrev_b32 v5, 4, v0
    v_lshrrev_b32 v1, 3, v0
    v_and_b32 v2, 7, v0
    v_add_u32 v120, s90, v5
    v_xor_b32 v2, v2, v1
    v_mul_u32_u24 v1, 6144, v1
    v_lshl_add_u32 v1, v2, 4, v1
    v_add_u32 v121, s34, v1
    v_add_u32 v122, 49152, v121
    v_add_u32 v123, 98304, v121
    v_add_u32 v124, 147456, v121
    s_branch L_epi2
.p2align 6
.type L_table,@object
L_table:
    .long 0x12, 0x7bc000, 0x4e4800, 0x24000, 0x4e4800, 0x1e000, 0x6000, 0x3000, 0x10, 0x0, 0x1e000, 0x6000, 0x5, 0x4e4800, 0xc1300000, 0x0
    .long 0x12, 0x7bc000, 0x514800, 0x21000, 0x4e4800, 0x1e000, 0x6000, 0x3000, 0x10, 0x0, 0x1e000, 0x9000, 0x5, 0x4e4800, 0xc1300000, 0x0
    .long 0x12, 0x7bc000, 0x544800, 0x1b000, 0x4e4800, 0x1e000, 0x6000, 0x3000, 0x10, 0x0, 0x1e000, 0xc000, 0x5, 0x4e4800, 0xc1300000, 0x0
    .long 0x12, 0x7bc000, 0x574800, 0x18000, 0x4e4800, 0x1e000, 0x6000, 0x3000, 0x10, 0x0, 0x1e000, 0xf000, 0x5, 0x4e4800, 0xc1300000, 0x0
    .long 0x15, 0x7bc000, 0x5a4800, 0x15000, 0x4e4800, 0x1e000, 0x6000, 0x3000, 0x10, 0x0, 0x1e000, 0x12000, 0x5, 0x4e4800, 0xc1300000, 0x0
    .long 0x15, 0x7bc000, 0x5d4800, 0x12000, 0x4fc800, 0x1e800, 0x6000, 0x3800, 0x10, 0x0, 0x1e000, 0x15000, 0x5, 0x4e4800, 0xc1300000, 0x0
    .long 0x19, 0x7bc000, 0x604800, 0xf000, 0x4e4800, 0x1e000, 0x6000, 0x3000, 0x10, 0x0, 0x1e000, 0x18000, 0x5, 0x4e4800, 0xc1300000, 0x0
    .long 0x19, 0x7bc000, 0x634800, 0xc000, 0x4fc800, 0x1e800, 0x6000, 0x3800, 0x10, 0x0, 0x1e000, 0x1b000, 0x5, 0x4e4800, 0xc1300000, 0x0
    .long 0x12, 0x7bc000, 0x4e4980, 0x24000, 0x4e4980, 0x1e000, 0x6000, 0x3000, 0x10, 0x0, 0x1e000, 0x6000, 0x5, 0x4e4980, 0xc1300000, 0x0
    .long 0x12, 0x7bc000, 0x514980, 0x21000, 0x4e4980, 0x1e000, 0x6000, 0x3000, 0x10, 0x0, 0x1e000, 0x9000, 0x5, 0x4e4980, 0xc1300000, 0x0
    .long 0x12, 0x7bc000, 0x544980, 0x1b000, 0x4e4980, 0x1e000, 0x6000, 0x3000, 0x10, 0x0, 0x1e000, 0xc000, 0x5, 0x4e4980, 0xc1300000, 0x0
    .long 0x12, 0x7bc000, 0x574980, 0x18000, 0x4e4980, 0x1e000, 0x6000, 0x3000, 0x10, 0x0, 0x1e000, 0xf000, 0x5, 0x4e4980, 0xc1300000, 0x0
    .long 0x15, 0x7bc000, 0x5a4980, 0x15000, 0x4e4980, 0x1e000, 0x6000, 0x3000, 0x10, 0x0, 0x1e000, 0x12000, 0x5, 0x4e4980, 0xc1300000, 0x0
    .long 0x15, 0x7bc000, 0x5d4980, 0x12000, 0x4fc980, 0x1e800, 0x6000, 0x3800, 0x10, 0x0, 0x1e000, 0x15000, 0x5, 0x4e4980, 0xc1300000, 0x0
    .long 0x19, 0x7bc000, 0x604980, 0xf000, 0x4e4980, 0x1e000, 0x6000, 0x3000, 0x10, 0x0, 0x1e000, 0x18000, 0x5, 0x4e4980, 0xc1300000, 0x0
    .long 0x19, 0x7bc000, 0x634980, 0xc000, 0x4fc980, 0x1e800, 0x6000, 0x3800, 0x10, 0x0, 0x1e000, 0x1b000, 0x5, 0x4e4980, 0xc1300000, 0x0
    .long 0x12, 0x7bc000, 0x5a4800, 0x24000, 0x4e4800, 0x1e000, 0x6000, 0x3000, 0x10, 0x0, 0x1e000, 0x6000, 0x5, 0x4e4800, 0xc1300000, 0x0
    .long 0x12, 0x7bc000, 0x5d4800, 0x21000, 0x4e4800, 0x1e000, 0x6000, 0x3000, 0x10, 0x0, 0x1e000, 0x9000, 0x5, 0x4e4800, 0xc1300000, 0x0
    .long 0x12, 0x7bc000, 0x604800, 0x1b000, 0x4e4800, 0x1e000, 0x6000, 0x3000, 0x10, 0x0, 0x1e000, 0xc000, 0x5, 0x4e4800, 0xc1300000, 0x0
    .long 0x12, 0x7bc000, 0x634800, 0x18000, 0x4e4800, 0x1e000, 0x6000, 0x3000, 0x10, 0x0, 0x1e000, 0xf000, 0x5, 0x4e4800, 0xc1300000, 0x0
    .long 0x15, 0x7bc000, 0x664800, 0x15000, 0x4e4800, 0x1e000, 0x6000, 0x3000, 0x10, 0x0, 0x1e000, 0x12000, 0x5, 0x4e4800, 0xc1300000, 0x0
    .long 0x15, 0x7bc000, 0x694800, 0x12000, 0x4fc800, 0x1e800, 0x6000, 0x3800, 0x10, 0x0, 0x1e000, 0x15000, 0x5, 0x4e4800, 0xc1300000, 0x0
    .long 0x19, 0x7bc000, 0x6c4800, 0xf000, 0x4e4800, 0x1e000, 0x6000, 0x3000, 0x10, 0x0, 0x1e000, 0x18000, 0x5, 0x4e4800, 0xc1300000, 0x0
    .long 0x19, 0x7bc000, 0x6f4800, 0xc000, 0x4fc800, 0x1e800, 0x6000, 0x3800, 0x10, 0x0, 0x1e000, 0x1b000, 0x5, 0x4e4800, 0xc1300000, 0x0
    .long 0x12, 0x7bc000, 0x5a4980, 0x24000, 0x4e4980, 0x1e000, 0x6000, 0x3000, 0x10, 0x0, 0x1e000, 0x6000, 0x5, 0x4e4980, 0xc1300000, 0x0
    .long 0x12, 0x7bc000, 0x5d4980, 0x21000, 0x4e4980, 0x1e000, 0x6000, 0x3000, 0x10, 0x0, 0x1e000, 0x9000, 0x5, 0x4e4980, 0xc1300000, 0x0
    .long 0x12, 0x7bc000, 0x604980, 0x1b000, 0x4e4980, 0x1e000, 0x6000, 0x3000, 0x10, 0x0, 0x1e000, 0xc000, 0x5, 0x4e4980, 0xc1300000, 0x0
    .long 0x12, 0x7bc000, 0x634980, 0x18000, 0x4e4980, 0x1e000, 0x6000, 0x3000, 0x10, 0x0, 0x1e000, 0xf000, 0x5, 0x4e4980, 0xc1300000, 0x0
    .long 0x15, 0x7bc000, 0x664980, 0x15000, 0x4e4980, 0x1e000, 0x6000, 0x3000, 0x10, 0x0, 0x1e000, 0x12000, 0x5, 0x4e4980, 0xc1300000, 0x0
    .long 0x15, 0x7bc000, 0x694980, 0x12000, 0x4fc980, 0x1e800, 0x6000, 0x3800, 0x10, 0x0, 0x1e000, 0x15000, 0x5, 0x4e4980, 0xc1300000, 0x0
    .long 0x19, 0x7bc000, 0x6c4980, 0xf000, 0x4e4980, 0x1e000, 0x6000, 0x3000, 0x10, 0x0, 0x1e000, 0x18000, 0x5, 0x4e4980, 0xc1300000, 0x0
    .long 0x19, 0x7bc000, 0x6f4980, 0xc000, 0x4fc980, 0x1e800, 0x6000, 0x3800, 0x10, 0x0, 0x1e000, 0x1b000, 0x5, 0x4e4980, 0xc1300000, 0x0
    .long 0x12, 0x7bc000, 0x664800, 0x24000, 0x4e4800, 0x1e000, 0x6000, 0x3000, 0x10, 0x0, 0x1e000, 0x6000, 0x5, 0x4e4800, 0xc1300000, 0x0
    .long 0x12, 0x7bc000, 0x694800, 0x21000, 0x4e4800, 0x1e000, 0x6000, 0x3000, 0x10, 0x0, 0x1e000, 0x9000, 0x5, 0x4e4800, 0xc1300000, 0x0
    .long 0x12, 0x7bc000, 0x6c4800, 0x1b000, 0x4e4800, 0x1e000, 0x6000, 0x3000, 0x10, 0x0, 0x1e000, 0xc000, 0x5, 0x4e4800, 0xc1300000, 0x0
    .long 0x12, 0x7bc000, 0x6f4800, 0x18000, 0x4e4800, 0x1e000, 0x6000, 0x3000, 0x10, 0x0, 0x1e000, 0xf000, 0x5, 0x4e4800, 0xc1300000, 0x0
    .long 0x15, 0x7bc000, 0x724800, 0x15000, 0x4e4800, 0x1e000, 0x6000, 0x3000, 0x10, 0x0, 0x1e000, 0x12000, 0x5, 0x4e4800, 0xc1300000, 0x0
    .long 0x15, 0x7bc000, 0x754800, 0x12000, 0x4fc800, 0x1e800, 0x6000, 0x3800, 0x10, 0x0, 0x1e000, 0x15000, 0x5, 0x4e4800, 0xc1300000, 0x0
    .long 0x19, 0x7bc000, 0x784800, 0xf000, 0x4e4800, 0x1e000, 0x6000, 0x3000, 0x10, 0x0, 0x1e000, 0x18000, 0x5, 0x4e4800, 0xc1300000, 0x0
    .long 0x19, 0x7bc000, 0x7b4800, 0xc000, 0x4fc800, 0x1e800, 0x6000, 0x3800, 0x10, 0x0, 0x1e000, 0x1b000, 0x5, 0x4e4800, 0xc1300000, 0x0
    .long 0x12, 0x7bc000, 0x664980, 0x24000, 0x4e4980, 0x1e000, 0x6000, 0x3000, 0x10, 0x0, 0x1e000, 0x6000, 0x5, 0x4e4980, 0xc1300000, 0x0
    .long 0x12, 0x7bc000, 0x694980, 0x21000, 0x4e4980, 0x1e000, 0x6000, 0x3000, 0x10, 0x0, 0x1e000, 0x9000, 0x5, 0x4e4980, 0xc1300000, 0x0
    .long 0x12, 0x7bc000, 0x6c4980, 0x1b000, 0x4e4980, 0x1e000, 0x6000, 0x3000, 0x10, 0x0, 0x1e000, 0xc000, 0x5, 0x4e4980, 0xc1300000, 0x0
    .long 0x12, 0x7bc000, 0x6f4980, 0x18000, 0x4e4980, 0x1e000, 0x6000, 0x3000, 0x10, 0x0, 0x1e000, 0xf000, 0x5, 0x4e4980, 0xc1300000, 0x0
    .long 0x15, 0x7bc000, 0x724980, 0x15000, 0x4e4980, 0x1e000, 0x6000, 0x3000, 0x10, 0x0, 0x1e000, 0x12000, 0x5, 0x4e4980, 0xc1300000, 0x0
    .long 0x15, 0x7bc000, 0x754980, 0x12000, 0x4fc980, 0x1e800, 0x6000, 0x3800, 0x10, 0x0, 0x1e000, 0x15000, 0x5, 0x4e4980, 0xc1300000, 0x0
    .long 0x19, 0x7bc000, 0x784980, 0xf000, 0x4e4980, 0x1e000, 0x6000, 0x3000, 0x10, 0x0, 0x1e000, 0x18000, 0x5, 0x4e4980, 0xc1300000, 0x0
    .long 0x19, 0x7bc000, 0x7b4980, 0xc000, 0x4fc980, 0x1e800, 0x6000, 0x3800, 0x10, 0x0, 0x1e000, 0x1b000, 0x5, 0x4e4980, 0xc1300000, 0x0
    .long 0x12, 0x7bc000, 0x724800, 0x24000, 0x4e4800, 0x1e000, 0x6000, 0x3000, 0x10, 0x0, 0x1e000, 0x6000, 0x5, 0x4e4800, 0xc1300000, 0x0
    .long 0x12, 0x7bc000, 0x754800, 0x21000, 0x4e4800, 0x1e000, 0x6000, 0x3000, 0x10, 0x0, 0x1e000, 0x9000, 0x5, 0x4e4800, 0xc1300000, 0x0
    .long 0x12, 0x7bc000, 0x784800, 0x1b000, 0x4e4800, 0x1e000, 0x6000, 0x3000, 0x10, 0x0, 0x1e000, 0xc000, 0x5, 0x4e4800, 0xc1300000, 0x0
    .long 0x12, 0x7bc000, 0x7b4800, 0x18000, 0x4e4800, 0x1e000, 0x6000, 0x3000, 0x10, 0x0, 0x1e000, 0xf000, 0x5, 0x4e4800, 0xc1300000, 0x0
    .long 0x15, 0x7bc000, 0x7e4800, 0x15000, 0x4e4800, 0x1e000, 0x6000, 0x3000, 0x10, 0x0, 0x1e000, 0x12000, 0x5, 0x4e4800, 0xc1300000, 0x0
    .long 0x15, 0x7bc000, 0x814800, 0x12000, 0x4fc800, 0x1e800, 0x6000, 0x3800, 0x10, 0x0, 0x1e000, 0x15000, 0x5, 0x4e4800, 0xc1300000, 0x0
    .long 0x19, 0x7bc000, 0x844800, 0xf000, 0x4e4800, 0x1e000, 0x6000, 0x3000, 0x10, 0x0, 0x1e000, 0x18000, 0x5, 0x4e4800, 0xc1300000, 0x0
    .long 0x19, 0x7bc000, 0x874800, 0xc000, 0x4fc800, 0x1e800, 0x6000, 0x3800, 0x10, 0x0, 0x1e000, 0x1b000, 0x5, 0x4e4800, 0xc1300000, 0x0
    .long 0x12, 0x7bc000, 0x724980, 0x24000, 0x4e4980, 0x1e000, 0x6000, 0x3000, 0x10, 0x0, 0x1e000, 0x6000, 0x5, 0x4e4980, 0xc1300000, 0x0
    .long 0x12, 0x7bc000, 0x754980, 0x21000, 0x4e4980, 0x1e000, 0x6000, 0x3000, 0x10, 0x0, 0x1e000, 0x9000, 0x5, 0x4e4980, 0xc1300000, 0x0
    .long 0x12, 0x7bc000, 0x784980, 0x1b000, 0x4e4980, 0x1e000, 0x6000, 0x3000, 0x10, 0x0, 0x1e000, 0xc000, 0x5, 0x4e4980, 0xc1300000, 0x0
    .long 0x12, 0x7bc000, 0x7b4980, 0x18000, 0x4e4980, 0x1e000, 0x6000, 0x3000, 0x10, 0x0, 0x1e000, 0xf000, 0x5, 0x4e4980, 0xc1300000, 0x0
    .long 0x15, 0x7bc000, 0x7e4980, 0x15000, 0x4e4980, 0x1e000, 0x6000, 0x3000, 0x10, 0x0, 0x1e000, 0x12000, 0x5, 0x4e4980, 0xc1300000, 0x0
    .long 0x15, 0x7bc000, 0x814980, 0x12000, 0x4fc980, 0x1e800, 0x6000, 0x3800, 0x10, 0x0, 0x1e000, 0x15000, 0x5, 0x4e4980, 0xc1300000, 0x0
    .long 0x19, 0x7bc000, 0x844980, 0xf000, 0x4e4980, 0x1e000, 0x6000, 0x3000, 0x10, 0x0, 0x1e000, 0x18000, 0x5, 0x4e4980, 0xc1300000, 0x0
    .long 0x19, 0x7bc000, 0x874980, 0xc000, 0x4fc980, 0x1e800, 0x6000, 0x3800, 0x10, 0x0, 0x1e000, 0x1b000, 0x5, 0x4e4980, 0xc1300000, 0x0
    .long 0x22, 0xc0f000, 0xaed800, 0x24000, 0xaed800, 0x1e000, 0x6000, 0x3000, 0x7, 0x0, 0x1e000, 0x6000, 0x1, 0xaed800, 0xc1700000, 0x0
    .long 0x22, 0xc0f000, 0xb1d800, 0x21000, 0xaed800, 0x1e000, 0x6000, 0x3000, 0x7, 0x0, 0x1e000, 0x9000, 0x1, 0xaed800, 0xc1700000, 0x0
    .long 0x22, 0xc0f000, 0xb4d800, 0x1b000, 0xaed800, 0x1e000, 0x6000, 0x3000, 0x7, 0x0, 0x1e000, 0xc000, 0x1, 0xaed800, 0xc1700000, 0x0
    .long 0x22, 0xc0f000, 0xb7d800, 0x18000, 0xaed800, 0x1e000, 0x6000, 0x3000, 0x7, 0x0, 0x1e000, 0xf000, 0x1, 0xaed800, 0xc1700000, 0x0
    .long 0x22, 0xc0f000, 0xbad800, 0x15000, 0xaed800, 0x1e000, 0x6000, 0x3000, 0x7, 0x0, 0x1e000, 0x12000, 0x1, 0xaed800, 0xc1700000, 0x0
    .long 0x22, 0xc0f000, 0xbdd800, 0x12000, 0xaed800, 0x1e000, 0x6000, 0x3000, 0x7, 0x0, 0x1e000, 0x15000, 0x1, 0xaed800, 0xc1700000, 0x0
    .long 0x22, 0xc0f000, 0xc0d800, 0xf000, 0xaed800, 0x1e000, 0x6000, 0x3000, 0x7, 0x0, 0x1e000, 0x18000, 0x1, 0xaed800, 0xc1700000, 0x0
    .long 0x6d, 0xc0f000, 0xc3d800, 0xc000, 0xaed800, 0x1e000, 0x6000, 0x3000, 0x7, 0x0, 0x1e000, 0x1b000, 0x1, 0xaed800, 0xc1700000, 0x0
    .long 0x22, 0xc0f000, 0xaed980, 0x24000, 0xaed980, 0x1e000, 0x6000, 0x3000, 0x7, 0x0, 0x1e000, 0x6000, 0x1, 0xaed980, 0xc1700000, 0x0
    .long 0x22, 0xc0f000, 0xb1d980, 0x21000, 0xaed980, 0x1e000, 0x6000, 0x3000, 0x7, 0x0, 0x1e000, 0x9000, 0x1, 0xaed980, 0xc1700000, 0x0
    .long 0x22, 0xc0f000, 0xb4d980, 0x1b000, 0xaed980, 0x1e000, 0x6000, 0x3000, 0x7, 0x0, 0x1e000, 0xc000, 0x1, 0xaed980, 0xc1700000, 0x0
    .long 0x22, 0xc0f000, 0xb7d980, 0x18000, 0xaed980, 0x1e000, 0x6000, 0x3000, 0x7, 0x0, 0x1e000, 0xf000, 0x1, 0xaed980, 0xc1700000, 0x0
    .long 0x22, 0xc0f000, 0xbad980, 0x15000, 0xaed980, 0x1e000, 0x6000, 0x3000, 0x7, 0x0, 0x1e000, 0x12000, 0x1, 0xaed980, 0xc1700000, 0x0
    .long 0x22, 0xc0f000, 0xbdd980, 0x12000, 0xaed980, 0x1e000, 0x6000, 0x3000, 0x7, 0x0, 0x1e000, 0x15000, 0x1, 0xaed980, 0xc1700000, 0x0
    .long 0x22, 0xc0f000, 0xc0d980, 0xf000, 0xaed980, 0x1e000, 0x6000, 0x3000, 0x7, 0x0, 0x1e000, 0x18000, 0x1, 0xaed980, 0xc1700000, 0x0
    .long 0x6d, 0xc0f000, 0xc3d980, 0xc000, 0xaed980, 0x1e000, 0x6000, 0x3000, 0x7, 0x0, 0x1e000, 0x1b000, 0x1, 0xaed980, 0xc1700000, 0x0
    .long 0x32, 0x4e4800, 0x3eb800, 0x24000, 0x3eb800, 0x1e000, 0x6000, 0x3000, 0x6, 0x0, 0x1e000, 0x6000, 0x6, 0x3eb800, 0xc1200000, 0x0
    .long 0x32, 0x4e4800, 0x41b800, 0x21000, 0x3eb800, 0x1e000, 0x6000, 0x3000, 0x6, 0x0, 0x1e000, 0x9000, 0x6, 0x3eb800, 0xc1200000, 0x0
    .long 0x32, 0x4e4800, 0x44b800, 0x1b000, 0x3eb800, 0x1e000, 0x6000, 0x3000, 0x6, 0x0, 0x1e000, 0xc000, 0x6, 0x3eb800, 0xc1200000, 0x0
    .long 0x32, 0x4e4800, 0x47b800, 0x18000, 0x3eb800, 0x1e000, 0x6000, 0x3000, 0x6, 0x0, 0x1e000, 0xf000, 0x6, 0x3eb800, 0xc1200000, 0x0
    .long 0x32, 0x4e4800, 0x4ab800, 0x15000, 0x3eb800, 0x1e000, 0x6000, 0x3000, 0x6, 0x0, 0x1e000, 0x12000, 0x6, 0x3eb800, 0xc1200000, 0x0
    .long 0x32, 0x4e4800, 0x4db800, 0x12000, 0x3eb800, 0x1e000, 0x6000, 0x3000, 0x6, 0x0, 0x1e000, 0x15000, 0x6, 0x3eb800, 0xc1200000, 0x0
    .long 0x75, 0x4e4800, 0x50b800, 0xf000, 0x3eb800, 0x1e000, 0x6000, 0x3000, 0x6, 0x0, 0x1e000, 0x18000, 0x6, 0x3eb800, 0xc1200000, 0x0
    .long 0x79, 0x4e4800, 0x53b800, 0xc000, 0x3eb800, 0x1e000, 0x6000, 0x3000, 0x6, 0x0, 0x1e000, 0x1b000, 0x6, 0x3eb800, 0xc1200000, 0x0
    .long 0x32, 0x4e4800, 0x3eb980, 0x24000, 0x3eb980, 0x1e000, 0x6000, 0x3000, 0x6, 0x0, 0x1e000, 0x6000, 0x6, 0x3eb980, 0xc1200000, 0x0
    .long 0x32, 0x4e4800, 0x41b980, 0x21000, 0x3eb980, 0x1e000, 0x6000, 0x3000, 0x6, 0x0, 0x1e000, 0x9000, 0x6, 0x3eb980, 0xc1200000, 0x0
    .long 0x32, 0x4e4800, 0x44b980, 0x1b000, 0x3eb980, 0x1e000, 0x6000, 0x3000, 0x6, 0x0, 0x1e000, 0xc000, 0x6, 0x3eb980, 0xc1200000, 0x0
    .long 0x32, 0x4e4800, 0x47b980, 0x18000, 0x3eb980, 0x1e000, 0x6000, 0x3000, 0x6, 0x0, 0x1e000, 0xf000, 0x6, 0x3eb980, 0xc1200000, 0x0
    .long 0x32, 0x4e4800, 0x4ab980, 0x15000, 0x3eb980, 0x1e000, 0x6000, 0x3000, 0x6, 0x0, 0x1e000, 0x12000, 0x6, 0x3eb980, 0xc1200000, 0x0
    .long 0x32, 0x4e4800, 0x4db980, 0x12000, 0x3eb980, 0x1e000, 0x6000, 0x3000, 0x6, 0x0, 0x1e000, 0x15000, 0x6, 0x3eb980, 0xc1200000, 0x0
    .long 0x75, 0x4e4800, 0x50b980, 0xf000, 0x3eb980, 0x1e000, 0x6000, 0x3000, 0x6, 0x0, 0x1e000, 0x18000, 0x6, 0x3eb980, 0xc1200000, 0x0
    .long 0x79, 0x4e4800, 0x53b980, 0xc000, 0x3eb980, 0x1e000, 0x6000, 0x3000, 0x6, 0x0, 0x1e000, 0x1b000, 0x6, 0x3eb980, 0xc1200000, 0x0
    .long 0x22, 0x234000, 0x165000, 0x24000, 0x165000, 0x1e000, 0x6000, 0x3000, 0x5, 0x0, 0x1e000, 0x6000, 0xa, 0x165000, 0xc0c00000, 0x0
    .long 0x22, 0x234000, 0x195000, 0x21000, 0x165000, 0x1e000, 0x6000, 0x3000, 0x5, 0x0, 0x1e000, 0x9000, 0xa, 0x165000, 0xc0c00000, 0x0
    .long 0x22, 0x234000, 0x1c5000, 0x1b000, 0x165000, 0x1e000, 0x6000, 0x3000, 0x5, 0x0, 0x1e000, 0xc000, 0xa, 0x165000, 0xc0c00000, 0x0
    .long 0x22, 0x234000, 0x1f5000, 0x18000, 0x165000, 0x1e000, 0x6000, 0x3000, 0x5, 0x0, 0x1e000, 0xf000, 0xa, 0x165000, 0xc0c00000, 0x0
    .long 0x22, 0x234000, 0x225000, 0x15000, 0x165000, 0x1e000, 0x6000, 0x3000, 0x5, 0x0, 0x1e000, 0x12000, 0xa, 0x165000, 0xc0c00000, 0x0
    .long 0x20, 0x234000, 0x255000, 0x12000, 0x165000, 0x1e000, 0x6000, 0x3000, 0x5, 0x0, 0x1e000, 0x15000, 0xa, 0x165000, 0xc0c00000, 0x0
    .long 0x65, 0x234000, 0x285000, 0xf000, 0x165000, 0x1e000, 0x6000, 0x3000, 0x5, 0x0, 0x1e000, 0x18000, 0xa, 0x165000, 0xc0c00000, 0x0
    .long 0x69, 0x234000, 0x2b5000, 0xc000, 0x165000, 0x1e000, 0x6000, 0x3000, 0x5, 0x0, 0x1e000, 0x1b000, 0xa, 0x165000, 0xc0c00000, 0x0
    .long 0x22, 0x234000, 0x165180, 0x24000, 0x165180, 0x1e000, 0x6000, 0x3000, 0x5, 0x0, 0x1e000, 0x6000, 0xa, 0x165180, 0xc0c00000, 0x0
    .long 0x22, 0x234000, 0x195180, 0x21000, 0x165180, 0x1e000, 0x6000, 0x3000, 0x5, 0x0, 0x1e000, 0x9000, 0xa, 0x165180, 0xc0c00000, 0x0
    .long 0x22, 0x234000, 0x1c5180, 0x1b000, 0x165180, 0x1e000, 0x6000, 0x3000, 0x5, 0x0, 0x1e000, 0xc000, 0xa, 0x165180, 0xc0c00000, 0x0
    .long 0x22, 0x234000, 0x1f5180, 0x18000, 0x165180, 0x1e000, 0x6000, 0x3000, 0x5, 0x0, 0x1e000, 0xf000, 0xa, 0x165180, 0xc0c00000, 0x0
    .long 0x22, 0x234000, 0x225180, 0x15000, 0x165180, 0x1e000, 0x6000, 0x3000, 0x5, 0x0, 0x1e000, 0x12000, 0xa, 0x165180, 0xc0c00000, 0x0
    .long 0x20, 0x234000, 0x255180, 0x12000, 0x165180, 0x1e000, 0x6000, 0x3000, 0x5, 0x0, 0x1e000, 0x15000, 0xa, 0x165180, 0xc0c00000, 0x0
    .long 0x65, 0x234000, 0x285180, 0xf000, 0x165180, 0x1e000, 0x6000, 0x3000, 0x5, 0x0, 0x1e000, 0x18000, 0xa, 0x165180, 0xc0c00000, 0x0
    .long 0x69, 0x234000, 0x2b5180, 0xc000, 0x165180, 0x1e000, 0x6000, 0x3000, 0x5, 0x0, 0x1e000, 0x1b000, 0xa, 0x165180, 0xc0c00000, 0x0
    .long 0x10000012, 0xaed800, 0x90d800, 0x24000, 0x90d800, 0x1e000, 0x6000, 0x3000, 0xa, 0x0, 0x1e000, 0x6000, 0x20, 0x90d800, 0x0, 0x0
    .long 0x10000012, 0xaed800, 0x93d800, 0x21000, 0x90d800, 0x1e000, 0x6000, 0x3000, 0xa, 0x0, 0x1e000, 0x9000, 0x20, 0x90d800, 0x0, 0x0
    .long 0x10000012, 0xaed800, 0x96d800, 0x1b000, 0x90d800, 0x1e000, 0x6000, 0x3000, 0xa, 0x0, 0x1e000, 0xc000, 0x20, 0x90d800, 0x0, 0x0
    .long 0x10000012, 0xaed800, 0x99d800, 0x18000, 0x90d800, 0x1e000, 0x6000, 0x3000, 0xa, 0x0, 0x1e000, 0xf000, 0x20, 0x90d800, 0x0, 0x0
    .long 0x10000015, 0xaed800, 0x9cd800, 0x15000, 0x90d800, 0x1e000, 0x6000, 0x3000, 0xa, 0x0, 0x1e000, 0x12000, 0x20, 0x90d800, 0x0, 0x2
    .long 0x10000015, 0xaed800, 0x9fd800, 0x12000, 0x925800, 0x1e800, 0x6000, 0x3800, 0xa, 0x0, 0x1e000, 0x15000, 0x20, 0x90d800, 0x0, 0x2
    .long 0x10000019, 0xaed800, 0xa2d800, 0xf000, 0x90d800, 0x1e000, 0x6000, 0x3000, 0xa, 0x0, 0x1e000, 0x18000, 0x20, 0x90d800, 0x0, 0x2
    .long 0x10000019, 0xaed800, 0xa5d800, 0xc000, 0x925800, 0x1e800, 0x6000, 0x3800, 0xa, 0x0, 0x1e000, 0x1b000, 0x20, 0x90d800, 0x0, 0x2
    .long 0x10000012, 0xaed800, 0x90d980, 0x24000, 0x90d980, 0x1e000, 0x6000, 0x3000, 0xa, 0x0, 0x1e000, 0x6000, 0x20, 0x90d980, 0x0, 0x0
    .long 0x10000012, 0xaed800, 0x93d980, 0x21000, 0x90d980, 0x1e000, 0x6000, 0x3000, 0xa, 0x0, 0x1e000, 0x9000, 0x20, 0x90d980, 0x0, 0x0
    .long 0x10000012, 0xaed800, 0x96d980, 0x1b000, 0x90d980, 0x1e000, 0x6000, 0x3000, 0xa, 0x0, 0x1e000, 0xc000, 0x20, 0x90d980, 0x0, 0x0
    .long 0x10000012, 0xaed800, 0x99d980, 0x18000, 0x90d980, 0x1e000, 0x6000, 0x3000, 0xa, 0x0, 0x1e000, 0xf000, 0x20, 0x90d980, 0x0, 0x0
    .long 0x10000015, 0xaed800, 0x9cd980, 0x15000, 0x90d980, 0x1e000, 0x6000, 0x3000, 0xa, 0x0, 0x1e000, 0x12000, 0x20, 0x90d980, 0x0, 0x2
    .long 0x10000015, 0xaed800, 0x9fd980, 0x12000, 0x925980, 0x1e800, 0x6000, 0x3800, 0xa, 0x0, 0x1e000, 0x15000, 0x20, 0x90d980, 0x0, 0x2
    .long 0x10000019, 0xaed800, 0xa2d980, 0xf000, 0x90d980, 0x1e000, 0x6000, 0x3000, 0xa, 0x0, 0x1e000, 0x18000, 0x20, 0x90d980, 0x0, 0x2
    .long 0x10000019, 0xaed800, 0xa5d980, 0xc000, 0x925980, 0x1e800, 0x6000, 0x3800, 0xa, 0x0, 0x1e000, 0x1b000, 0x20, 0x90d980, 0x0, 0x2
    .long 0x10000012, 0xaed800, 0x9cd800, 0x24000, 0x90d800, 0x1e000, 0x6000, 0x3000, 0xa, 0x0, 0x1e000, 0x6000, 0x20, 0x90d800, 0x0, 0x0
    .long 0x10000012, 0xaed800, 0x9fd800, 0x21000, 0x90d800, 0x1e000, 0x6000, 0x3000, 0xa, 0x0, 0x1e000, 0x9000, 0x20, 0x90d800, 0x0, 0x0
    .long 0x10000012, 0xaed800, 0xa2d800, 0x1b000, 0x90d800, 0x1e000, 0x6000, 0x3000, 0xa, 0x0, 0x1e000, 0xc000, 0x20, 0x90d800, 0x0, 0x0
    .long 0x10000012, 0xaed800, 0xa5d800, 0x18000, 0x90d800, 0x1e000, 0x6000, 0x3000, 0xa, 0x0, 0x1e000, 0xf000, 0x20, 0x90d800, 0x0, 0x0
    .long 0x10000015, 0xaed800, 0xa8d800, 0x15000, 0x90d800, 0x1e000, 0x6000, 0x3000, 0xa, 0x0, 0x1e000, 0x12000, 0x20, 0x90d800, 0x0, 0x2
    .long 0x10000015, 0xaed800, 0xabd800, 0x12000, 0x925800, 0x1e800, 0x6000, 0x3800, 0xa, 0x0, 0x1e000, 0x15000, 0x20, 0x90d800, 0x0, 0x2
    .long 0x10000019, 0xaed800, 0xaed800, 0xf000, 0x90d800, 0x1e000, 0x6000, 0x3000, 0xa, 0x0, 0x1e000, 0x18000, 0x20, 0x90d800, 0x0, 0x2
    .long 0x10000019, 0xaed800, 0xb1d800, 0xc000, 0x925800, 0x1e800, 0x6000, 0x3800, 0xa, 0x0, 0x1e000, 0x1b000, 0x20, 0x90d800, 0x0, 0x2
    .long 0x10000012, 0xaed800, 0x9cd980, 0x24000, 0x90d980, 0x1e000, 0x6000, 0x3000, 0xa, 0x0, 0x1e000, 0x6000, 0x20, 0x90d980, 0x0, 0x0
    .long 0x10000012, 0xaed800, 0x9fd980, 0x21000, 0x90d980, 0x1e000, 0x6000, 0x3000, 0xa, 0x0, 0x1e000, 0x9000, 0x20, 0x90d980, 0x0, 0x0
    .long 0x10000012, 0xaed800, 0xa2d980, 0x1b000, 0x90d980, 0x1e000, 0x6000, 0x3000, 0xa, 0x0, 0x1e000, 0xc000, 0x20, 0x90d980, 0x0, 0x0
    .long 0x10000012, 0xaed800, 0xa5d980, 0x18000, 0x90d980, 0x1e000, 0x6000, 0x3000, 0xa, 0x0, 0x1e000, 0xf000, 0x20, 0x90d980, 0x0, 0x0
    .long 0x10000015, 0xaed800, 0xa8d980, 0x15000, 0x90d980, 0x1e000, 0x6000, 0x3000, 0xa, 0x0, 0x1e000, 0x12000, 0x20, 0x90d980, 0x0, 0x2
    .long 0x10000015, 0xaed800, 0xabd980, 0x12000, 0x925980, 0x1e800, 0x6000, 0x3800, 0xa, 0x0, 0x1e000, 0x15000, 0x20, 0x90d980, 0x0, 0x2
    .long 0x10000019, 0xaed800, 0xaed980, 0xf000, 0x90d980, 0x1e000, 0x6000, 0x3000, 0xa, 0x0, 0x1e000, 0x18000, 0x20, 0x90d980, 0x0, 0x2
    .long 0x10000019, 0xaed800, 0xb1d980, 0xc000, 0x925980, 0x1e800, 0x6000, 0x3800, 0xa, 0x0, 0x1e000, 0x1b000, 0x20, 0x90d980, 0x0, 0x2
    .long 0x10000012, 0xaed800, 0xa8d800, 0x24000, 0x90d800, 0x18000, 0xc000, 0x3000, 0xa, 0x0, 0x18000, 0xc000, 0x20, 0x90d800, 0x0, 0x0
    .long 0x10000012, 0xaed800, 0xabd800, 0x1b000, 0x90d800, 0x18000, 0xc000, 0x3000, 0xa, 0x0, 0x18000, 0xf000, 0x20, 0x90d800, 0x0, 0x0
    .long 0x10000012, 0xaed800, 0xa8d980, 0x21000, 0x90d980, 0x1e000, 0xc000, 0x9000, 0xa, 0x6000, 0x1e000, 0xc000, 0x20, 0x90d980, 0x0, 0x0
    .long 0x10000012, 0xaed800, 0xabd980, 0x15000, 0x90d980, 0x1e000, 0xc000, 0x9000, 0xa, 0x6000, 0x1e000, 0xf000, 0x20, 0x90d980, 0x0, 0x0
    .long 0x10000055, 0xaed800, 0xa8d800, 0x24000, 0x90d800, 0x18000, 0xc000, 0x3000, 0xa, 0x0, 0x18000, 0x18000, 0x20, 0x90d800, 0x0, 0x0
    .long 0x10000059, 0xaed800, 0xabd800, 0x1b000, 0x90d800, 0x18000, 0xc000, 0x3000, 0xa, 0x0, 0x18000, 0x1b000, 0x20, 0x90d800, 0x0, 0x0
    .long 0x10000055, 0xaed800, 0xa8d980, 0x21000, 0x90d980, 0x1e000, 0xc000, 0x9000, 0xa, 0x6000, 0x1e000, 0x18000, 0x20, 0x90d980, 0x0, 0x0
    .long 0x10000059, 0xaed800, 0xabd980, 0x15000, 0x90d980, 0x1e000, 0xc000, 0x9000, 0xa, 0x6000, 0x1e000, 0x1b000, 0x20, 0x90d980, 0x0, 0x0
    .long 0x20000012, 0x3eb800, 0x234000, 0x24000, 0x234000, 0x1e000, 0x6000, 0x3000, 0xa, 0x0, 0x1e000, 0x6000, 0x5, 0x234000, 0xc1300000, 0x0
    .long 0x20000012, 0x3eb800, 0x264000, 0x21000, 0x234000, 0x1e000, 0x6000, 0x3000, 0xa, 0x0, 0x1e000, 0x9000, 0x5, 0x234000, 0xc1300000, 0x0
    .long 0x20000012, 0x3eb800, 0x294000, 0x1b000, 0x234000, 0x1e000, 0x6000, 0x3000, 0xa, 0x0, 0x1e000, 0xc000, 0x5, 0x234000, 0xc1300000, 0x0
    .long 0x20000012, 0x3eb800, 0x2c4000, 0x18000, 0x234000, 0x1e000, 0x6000, 0x3000, 0xa, 0x0, 0x1e000, 0xf000, 0x5, 0x234000, 0xc1300000, 0x0
    .long 0x20000015, 0x3eb800, 0x2f4000, 0x15000, 0x234000, 0x1e000, 0x6000, 0x3000, 0xa, 0x0, 0x1e000, 0x12000, 0x5, 0x234000, 0xc1300000, 0x2
    .long 0x20000015, 0x3eb800, 0x324000, 0x12000, 0x24c000, 0x1e800, 0x6000, 0x3800, 0xa, 0x0, 0x1e000, 0x15000, 0x5, 0x234000, 0xc1300000, 0x2
    .long 0x20000019, 0x3eb800, 0x354000, 0xf000, 0x234000, 0x1e000, 0x6000, 0x3000, 0xa, 0x0, 0x1e000, 0x18000, 0x5, 0x234000, 0xc1300000, 0x2
    .long 0x20000019, 0x3eb800, 0x384000, 0xc000, 0x24c000, 0x1e800, 0x6000, 0x3800, 0xa, 0x0, 0x1e000, 0x1b000, 0x5, 0x234000, 0xc1300000, 0x2
    .long 0x20000012, 0x3eb800, 0x234180, 0x24000, 0x234180, 0x1e000, 0x6000, 0x3000, 0xa, 0x0, 0x1e000, 0x6000, 0x5, 0x234180, 0xc1300000, 0x0
    .long 0x20000012, 0x3eb800, 0x264180, 0x21000, 0x234180, 0x1e000, 0x6000, 0x3000, 0xa, 0x0, 0x1e000, 0x9000, 0x5, 0x234180, 0xc1300000, 0x0
    .long 0x20000012, 0x3eb800, 0x294180, 0x1b000, 0x234180, 0x1e000, 0x6000, 0x3000, 0xa, 0x0, 0x1e000, 0xc000, 0x5, 0x234180, 0xc1300000, 0x0
    .long 0x20000012, 0x3eb800, 0x2c4180, 0x18000, 0x234180, 0x1e000, 0x6000, 0x3000, 0xa, 0x0, 0x1e000, 0xf000, 0x5, 0x234180, 0xc1300000, 0x0
    .long 0x20000015, 0x3eb800, 0x2f4180, 0x15000, 0x234180, 0x1e000, 0x6000, 0x3000, 0xa, 0x0, 0x1e000, 0x12000, 0x5, 0x234180, 0xc1300000, 0x2
    .long 0x20000015, 0x3eb800, 0x324180, 0x12000, 0x24c180, 0x1e800, 0x6000, 0x3800, 0xa, 0x0, 0x1e000, 0x15000, 0x5, 0x234180, 0xc1300000, 0x2
    .long 0x20000019, 0x3eb800, 0x354180, 0xf000, 0x234180, 0x1e000, 0x6000, 0x3000, 0xa, 0x0, 0x1e000, 0x18000, 0x5, 0x234180, 0xc1300000, 0x2
    .long 0x20000019, 0x3eb800, 0x384180, 0xc000, 0x24c180, 0x1e800, 0x6000, 0x3800, 0xa, 0x0, 0x1e000, 0x1b000, 0x5, 0x234180, 0xc1300000, 0x2
    .long 0x20000012, 0x3eb800, 0x2f4000, 0x24000, 0x234000, 0x1e000, 0x6000, 0x3000, 0xa, 0x0, 0x1e000, 0x6000, 0x5, 0x234000, 0xc1300000, 0x0
    .long 0x20000012, 0x3eb800, 0x324000, 0x21000, 0x234000, 0x1e000, 0x6000, 0x3000, 0xa, 0x0, 0x1e000, 0x9000, 0x5, 0x234000, 0xc1300000, 0x0
    .long 0x20000012, 0x3eb800, 0x354000, 0x1b000, 0x234000, 0x1e000, 0x6000, 0x3000, 0xa, 0x0, 0x1e000, 0xc000, 0x5, 0x234000, 0xc1300000, 0x0
    .long 0x20000012, 0x3eb800, 0x384000, 0x18000, 0x234000, 0x1e000, 0x6000, 0x3000, 0xa, 0x0, 0x1e000, 0xf000, 0x5, 0x234000, 0xc1300000, 0x0
    .long 0x20000015, 0x3eb800, 0x3b4000, 0x15000, 0x234000, 0x1e000, 0x6000, 0x3000, 0xa, 0x0, 0x1e000, 0x12000, 0x5, 0x234000, 0xc1300000, 0x2
    .long 0x20000015, 0x3eb800, 0x3e4000, 0x12000, 0x24c000, 0x1e800, 0x6000, 0x3800, 0xa, 0x0, 0x1e000, 0x15000, 0x5, 0x234000, 0xc1300000, 0x2
    .long 0x20000019, 0x3eb800, 0x414000, 0xf000, 0x234000, 0x1e000, 0x6000, 0x3000, 0xa, 0x0, 0x1e000, 0x18000, 0x5, 0x234000, 0xc1300000, 0x2
    .long 0x20000019, 0x3eb800, 0x444000, 0xc000, 0x24c000, 0x1e800, 0x6000, 0x3800, 0xa, 0x0, 0x1e000, 0x1b000, 0x5, 0x234000, 0xc1300000, 0x2
    .long 0x20000012, 0x3eb800, 0x2f4180, 0x24000, 0x234180, 0x1e000, 0x6000, 0x3000, 0xa, 0x0, 0x1e000, 0x6000, 0x5, 0x234180, 0xc1300000, 0x0
    .long 0x20000012, 0x3eb800, 0x324180, 0x21000, 0x234180, 0x1e000, 0x6000, 0x3000, 0xa, 0x0, 0x1e000, 0x9000, 0x5, 0x234180, 0xc1300000, 0x0
    .long 0x20000012, 0x3eb800, 0x354180, 0x1b000, 0x234180, 0x1e000, 0x6000, 0x3000, 0xa, 0x0, 0x1e000, 0xc000, 0x5, 0x234180, 0xc1300000, 0x0
    .long 0x20000012, 0x3eb800, 0x384180, 0x18000, 0x234180, 0x1e000, 0x6000, 0x3000, 0xa, 0x0, 0x1e000, 0xf000, 0x5, 0x234180, 0xc1300000, 0x0
    .long 0x20000015, 0x3eb800, 0x3b4180, 0x15000, 0x234180, 0x1e000, 0x6000, 0x3000, 0xa, 0x0, 0x1e000, 0x12000, 0x5, 0x234180, 0xc1300000, 0x2
    .long 0x20000015, 0x3eb800, 0x3e4180, 0x12000, 0x24c180, 0x1e800, 0x6000, 0x3800, 0xa, 0x0, 0x1e000, 0x15000, 0x5, 0x234180, 0xc1300000, 0x2
    .long 0x20000019, 0x3eb800, 0x414180, 0xf000, 0x234180, 0x1e000, 0x6000, 0x3000, 0xa, 0x0, 0x1e000, 0x18000, 0x5, 0x234180, 0xc1300000, 0x2
    .long 0x20000019, 0x3eb800, 0x444180, 0xc000, 0x24c180, 0x1e800, 0x6000, 0x3800, 0xa, 0x0, 0x1e000, 0x1b000, 0x5, 0x234180, 0xc1300000, 0x2
    .long 0x20000012, 0x3eb800, 0x3b4000, 0x24000, 0x234000, 0x18000, 0xc000, 0x3000, 0xa, 0x0, 0x18000, 0xc000, 0x5, 0x234000, 0xc1300000, 0x0
    .long 0x20000012, 0x3eb800, 0x3e4000, 0x1b000, 0x234000, 0x18000, 0xc000, 0x3000, 0xa, 0x0, 0x18000, 0xf000, 0x5, 0x234000, 0xc1300000, 0x0
    .long 0x20000012, 0x3eb800, 0x3b4180, 0x21000, 0x234180, 0x1e000, 0xc000, 0x9000, 0xa, 0x6000, 0x1e000, 0xc000, 0x5, 0x234180, 0xc1300000, 0x0
    .long 0x20000012, 0x3eb800, 0x3e4180, 0x15000, 0x234180, 0x1e000, 0xc000, 0x9000, 0xa, 0x6000, 0x1e000, 0xf000, 0x5, 0x234180, 0xc1300000, 0x0
    .long 0x20000055, 0x3eb800, 0x3b4000, 0x24000, 0x234000, 0x18000, 0xc000, 0x3000, 0xa, 0x0, 0x18000, 0x18000, 0x5, 0x234000, 0xc1300000, 0x0
    .long 0x20000059, 0x3eb800, 0x3e4000, 0x1b000, 0x234000, 0x18000, 0xc000, 0x3000, 0xa, 0x0, 0x18000, 0x1b000, 0x5, 0x234000, 0xc1300000, 0x0
    .long 0x20000055, 0x3eb800, 0x3b4180, 0x21000, 0x234180, 0x1e000, 0xc000, 0x9000, 0xa, 0x6000, 0x1e000, 0x18000, 0x5, 0x234180, 0xc1300000, 0x0
    .long 0x20000059, 0x3eb800, 0x3e4180, 0x15000, 0x234180, 0x1e000, 0xc000, 0x9000, 0xa, 0x6000, 0x1e000, 0x1b000, 0x5, 0x234180, 0xc1300000, 0x0
    .long 0x30000012, 0x165000, 0x0, 0x24000, 0x0, 0x1e000, 0x6000, 0x3000, 0x8, 0x0, 0x1e000, 0x6000, 0xe, 0x0, 0xc0000000, 0x0
    .long 0x30000012, 0x165000, 0x30000, 0x21000, 0x0, 0x1e000, 0x6000, 0x3000, 0x8, 0x0, 0x1e000, 0x9000, 0xe, 0x0, 0xc0000000, 0x0
    .long 0x30000012, 0x165000, 0x60000, 0x1b000, 0x0, 0x1e000, 0x6000, 0x3000, 0x8, 0x0, 0x1e000, 0xc000, 0xe, 0x0, 0xc0000000, 0x0
    .long 0x30000012, 0x165000, 0x90000, 0x18000, 0x0, 0x1e000, 0x6000, 0x3000, 0x8, 0x0, 0x1e000, 0xf000, 0xe, 0x0, 0xc0000000, 0x0
    .long 0x30000015, 0x165000, 0xc0000, 0x15000, 0x0, 0x1e000, 0x6000, 0x3000, 0x8, 0x0, 0x1e000, 0x12000, 0xe, 0x0, 0xc0000000, 0x2
    .long 0x30000015, 0x165000, 0xf0000, 0x12000, 0x18000, 0x1e800, 0x6000, 0x3800, 0x8, 0x0, 0x1e000, 0x15000, 0xe, 0x0, 0xc0000000, 0x2
    .long 0x30000019, 0x165000, 0x120000, 0xf000, 0x0, 0x1e000, 0x6000, 0x3000, 0x8, 0x0, 0x1e000, 0x18000, 0xe, 0x0, 0xc0000000, 0x2
    .long 0x30000019, 0x165000, 0x150000, 0xc000, 0x18000, 0x1e800, 0x6000, 0x3800, 0x8, 0x0, 0x1e000, 0x1b000, 0xe, 0x0, 0xc0000000, 0x2
    .long 0x30000012, 0x165000, 0x180, 0x24000, 0x180, 0x1e000, 0x6000, 0x3000, 0x8, 0x0, 0x1e000, 0x6000, 0xe, 0x180, 0xc0000000, 0x0
    .long 0x30000012, 0x165000, 0x30180, 0x21000, 0x180, 0x1e000, 0x6000, 0x3000, 0x8, 0x0, 0x1e000, 0x9000, 0xe, 0x180, 0xc0000000, 0x0
    .long 0x30000012, 0x165000, 0x60180, 0x1b000, 0x180, 0x1e000, 0x6000, 0x3000, 0x8, 0x0, 0x1e000, 0xc000, 0xe, 0x180, 0xc0000000, 0x0
    .long 0x30000012, 0x165000, 0x90180, 0x18000, 0x180, 0x1e000, 0x6000, 0x3000, 0x8, 0x0, 0x1e000, 0xf000, 0xe, 0x180, 0xc0000000, 0x0
    .long 0x30000015, 0x165000, 0xc0180, 0x15000, 0x180, 0x1e000, 0x6000, 0x3000, 0x8, 0x0, 0x1e000, 0x12000, 0xe, 0x180, 0xc0000000, 0x2
    .long 0x30000015, 0x165000, 0xf0180, 0x12000, 0x18180, 0x1e800, 0x6000, 0x3800, 0x8, 0x0, 0x1e000, 0x15000, 0xe, 0x180, 0xc0000000, 0x2
    .long 0x30000019, 0x165000, 0x120180, 0xf000, 0x180, 0x1e000, 0x6000, 0x3000, 0x8, 0x0, 0x1e000, 0x18000, 0xe, 0x180, 0xc0000000, 0x2
    .long 0x30000019, 0x165000, 0x150180, 0xc000, 0x18180, 0x1e800, 0x6000, 0x3800, 0x8, 0x0, 0x1e000, 0x1b000, 0xe, 0x180, 0xc0000000, 0x2
    .long 0x30000012, 0x165000, 0xc0000, 0x24000, 0x0, 0x1e000, 0x6000, 0x3000, 0x8, 0x0, 0x1e000, 0x6000, 0xe, 0x0, 0xc0000000, 0x0
    .long 0x30000012, 0x165000, 0xf0000, 0x21000, 0x0, 0x1e000, 0x6000, 0x3000, 0x8, 0x0, 0x1e000, 0x9000, 0xe, 0x0, 0xc0000000, 0x0
    .long 0x30000012, 0x165000, 0x120000, 0x1b000, 0x0, 0x1e000, 0x6000, 0x3000, 0x8, 0x0, 0x1e000, 0xc000, 0xe, 0x0, 0xc0000000, 0x0
    .long 0x30000012, 0x165000, 0x150000, 0x18000, 0x0, 0x1e000, 0x6000, 0x3000, 0x8, 0x0, 0x1e000, 0xf000, 0xe, 0x0, 0xc0000000, 0x0
    .long 0x30000015, 0x165000, 0x180000, 0x15000, 0x0, 0x1e000, 0x6000, 0x3000, 0x8, 0x0, 0x1e000, 0x12000, 0xe, 0x0, 0xc0000000, 0x2
    .long 0x30000015, 0x165000, 0x1b0000, 0x12000, 0x18000, 0x1e800, 0x6000, 0x3800, 0x8, 0x0, 0x1e000, 0x15000, 0xe, 0x0, 0xc0000000, 0x2
    .long 0x30000019, 0x165000, 0x1e0000, 0xf000, 0x0, 0x1e000, 0x6000, 0x3000, 0x8, 0x0, 0x1e000, 0x18000, 0xe, 0x0, 0xc0000000, 0x2
    .long 0x30000019, 0x165000, 0x210000, 0xc000, 0x18000, 0x1e800, 0x6000, 0x3800, 0x8, 0x0, 0x1e000, 0x1b000, 0xe, 0x0, 0xc0000000, 0x2
    .long 0x30000012, 0x165000, 0xc0180, 0x24000, 0x180, 0x1e000, 0x6000, 0x3000, 0x8, 0x0, 0x1e000, 0x6000, 0xe, 0x180, 0xc0000000, 0x0
    .long 0x30000012, 0x165000, 0xf0180, 0x21000, 0x180, 0x1e000, 0x6000, 0x3000, 0x8, 0x0, 0x1e000, 0x9000, 0xe, 0x180, 0xc0000000, 0x0
    .long 0x30000012, 0x165000, 0x120180, 0x1b000, 0x180, 0x1e000, 0x6000, 0x3000, 0x8, 0x0, 0x1e000, 0xc000, 0xe, 0x180, 0xc0000000, 0x0
    .long 0x30000012, 0x165000, 0x150180, 0x18000, 0x180, 0x1e000, 0x6000, 0x3000, 0x8, 0x0, 0x1e000, 0xf000, 0xe, 0x180, 0xc0000000, 0x0
    .long 0x30000015, 0x165000, 0x180180, 0x15000, 0x180, 0x1e000, 0x6000, 0x3000, 0x8, 0x0, 0x1e000, 0x12000, 0xe, 0x180, 0xc0000000, 0x2
    .long 0x30000015, 0x165000, 0x1b0180, 0x12000, 0x18180, 0x1e800, 0x6000, 0x3800, 0x8, 0x0, 0x1e000, 0x15000, 0xe, 0x180, 0xc0000000, 0x2
    .long 0x30000019, 0x165000, 0x1e0180, 0xf000, 0x180, 0x1e000, 0x6000, 0x3000, 0x8, 0x0, 0x1e000, 0x18000, 0xe, 0x180, 0xc0000000, 0x2
    .long 0x30000019, 0x165000, 0x210180, 0xc000, 0x18180, 0x1e800, 0x6000, 0x3800, 0x8, 0x0, 0x1e000, 0x1b000, 0xe, 0x180, 0xc0000000, 0x2
    .long 0x40000012, 0x90d800, 0x7bc000, 0x24000, 0x7bc000, 0x1e000, 0x6000, 0x3000, 0x8, 0x0, 0x1e000, 0x6000, 0x1, 0x7bc000, 0xc1700000, 0x0
    .long 0x40000012, 0x90d800, 0x7ec000, 0x21000, 0x7bc000, 0x1e000, 0x6000, 0x3000, 0x8, 0x0, 0x1e000, 0x9000, 0x1, 0x7bc000, 0xc1700000, 0x0
    .long 0x40000012, 0x90d800, 0x81c000, 0x1b000, 0x7bc000, 0x1e000, 0x6000, 0x3000, 0x8, 0x0, 0x1e000, 0xc000, 0x1, 0x7bc000, 0xc1700000, 0x0
    .long 0x40000012, 0x90d800, 0x84c000, 0x18000, 0x7bc000, 0x1e000, 0x6000, 0x3000, 0x8, 0x0, 0x1e000, 0xf000, 0x1, 0x7bc000, 0xc1700000, 0x0
    .long 0x40000015, 0x90d800, 0x87c000, 0x15000, 0x7bc000, 0x1e000, 0x6000, 0x3000, 0x8, 0x0, 0x1e000, 0x12000, 0x1, 0x7bc000, 0xc1700000, 0x2
    .long 0x40000015, 0x90d800, 0x8ac000, 0x12000, 0x7d4000, 0x1e800, 0x6000, 0x3800, 0x8, 0x0, 0x1e000, 0x15000, 0x1, 0x7bc000, 0xc1700000, 0x2
    .long 0x40000019, 0x90d800, 0x8dc000, 0xf000, 0x7bc000, 0x1e000, 0x6000, 0x3000, 0x8, 0x0, 0x1e000, 0x18000, 0x1, 0x7bc000, 0xc1700000, 0x2
    .long 0x40000019, 0x90d800, 0x90c000, 0xc000, 0x7d4000, 0x1e800, 0x6000, 0x3800, 0x8, 0x0, 0x1e000, 0x1b000, 0x1, 0x7bc000, 0xc1700000, 0x2
    .long 0x40000012, 0x90d800, 0x7bc180, 0x24000, 0x7bc180, 0x1e000, 0x6000, 0x3000, 0x8, 0x0, 0x1e000, 0x6000, 0x1, 0x7bc180, 0xc1700000, 0x0
    .long 0x40000012, 0x90d800, 0x7ec180, 0x21000, 0x7bc180, 0x1e000, 0x6000, 0x3000, 0x8, 0x0, 0x1e000, 0x9000, 0x1, 0x7bc180, 0xc1700000, 0x0
    .long 0x40000012, 0x90d800, 0x81c180, 0x1b000, 0x7bc180, 0x1e000, 0x6000, 0x3000, 0x8, 0x0, 0x1e000, 0xc000, 0x1, 0x7bc180, 0xc1700000, 0x0
    .long 0x40000012, 0x90d800, 0x84c180, 0x18000, 0x7bc180, 0x1e000, 0x6000, 0x3000, 0x8, 0x0, 0x1e000, 0xf000, 0x1, 0x7bc180, 0xc1700000, 0x0
    .long 0x40000015, 0x90d800, 0x87c180, 0x15000, 0x7bc180, 0x1e000, 0x6000, 0x3000, 0x8, 0x0, 0x1e000, 0x12000, 0x1, 0x7bc180, 0xc1700000, 0x2
    .long 0x40000015, 0x90d800, 0x8ac180, 0x12000, 0x7d4180, 0x1e800, 0x6000, 0x3800, 0x8, 0x0, 0x1e000, 0x15000, 0x1, 0x7bc180, 0xc1700000, 0x2
    .long 0x40000019, 0x90d800, 0x8dc180, 0xf000, 0x7bc180, 0x1e000, 0x6000, 0x3000, 0x8, 0x0, 0x1e000, 0x18000, 0x1, 0x7bc180, 0xc1700000, 0x2
    .long 0x40000019, 0x90d800, 0x90c180, 0xc000, 0x7d4180, 0x1e800, 0x6000, 0x3800, 0x8, 0x0, 0x1e000, 0x1b000, 0x1, 0x7bc180, 0xc1700000, 0x2
    .long 0x40000012, 0x90d800, 0x87c000, 0x24000, 0x7bc000, 0x1e000, 0x6000, 0x3000, 0x8, 0x0, 0x1e000, 0x6000, 0x1, 0x7bc000, 0xc1700000, 0x0
    .long 0x40000012, 0x90d800, 0x8ac000, 0x21000, 0x7bc000, 0x1e000, 0x6000, 0x3000, 0x8, 0x0, 0x1e000, 0x9000, 0x1, 0x7bc000, 0xc1700000, 0x0
    .long 0x40000012, 0x90d800, 0x8dc000, 0x1b000, 0x7bc000, 0x1e000, 0x6000, 0x3000, 0x8, 0x0, 0x1e000, 0xc000, 0x1, 0x7bc000, 0xc1700000, 0x0
    .long 0x40000012, 0x90d800, 0x90c000, 0x18000, 0x7bc000, 0x1e000, 0x6000, 0x3000, 0x8, 0x0, 0x1e000, 0xf000, 0x1, 0x7bc000, 0xc1700000, 0x0
    .long 0x40000015, 0x90d800, 0x93c000, 0x15000, 0x7bc000, 0x1e000, 0x6000, 0x3000, 0x8, 0x0, 0x1e000, 0x12000, 0x1, 0x7bc000, 0xc1700000, 0x2
    .long 0x40000015, 0x90d800, 0x96c000, 0x12000, 0x7d4000, 0x1e800, 0x6000, 0x3800, 0x8, 0x0, 0x1e000, 0x15000, 0x1, 0x7bc000, 0xc1700000, 0x2
    .long 0x40000019, 0x90d800, 0x99c000, 0xf000, 0x7bc000, 0x1e000, 0x6000, 0x3000, 0x8, 0x0, 0x1e000, 0x18000, 0x1, 0x7bc000, 0xc1700000, 0x2
    .long 0x40000019, 0x90d800, 0x9cc000, 0xc000, 0x7d4000, 0x1e800, 0x6000, 0x3800, 0x8, 0x0, 0x1e000, 0x1b000, 0x1, 0x7bc000, 0xc1700000, 0x2
    .long 0x40000012, 0x90d800, 0x87c180, 0x24000, 0x7bc180, 0x1e000, 0x6000, 0x3000, 0x8, 0x0, 0x1e000, 0x6000, 0x1, 0x7bc180, 0xc1700000, 0x0
    .long 0x40000012, 0x90d800, 0x8ac180, 0x21000, 0x7bc180, 0x1e000, 0x6000, 0x3000, 0x8, 0x0, 0x1e000, 0x9000, 0x1, 0x7bc180, 0xc1700000, 0x0
    .long 0x40000012, 0x90d800, 0x8dc180, 0x1b000, 0x7bc180, 0x1e000, 0x6000, 0x3000, 0x8, 0x0, 0x1e000, 0xc000, 0x1, 0x7bc180, 0xc1700000, 0x0
    .long 0x40000012, 0x90d800, 0x90c180, 0x18000, 0x7bc180, 0x1e000, 0x6000, 0x3000, 0x8, 0x0, 0x1e000, 0xf000, 0x1, 0x7bc180, 0xc1700000, 0x0
    .long 0x40000015, 0x90d800, 0x93c180, 0x15000, 0x7bc180, 0x1e000, 0x6000, 0x3000, 0x8, 0x0, 0x1e000, 0x12000, 0x1, 0x7bc180, 0xc1700000, 0x2
    .long 0x40000015, 0x90d800, 0x96c180, 0x12000, 0x7d4180, 0x1e800, 0x6000, 0x3800, 0x8, 0x0, 0x1e000, 0x15000, 0x1, 0x7bc180, 0xc1700000, 0x2
    .long 0x40000019, 0x90d800, 0x99c180, 0xf000, 0x7bc180, 0x1e000, 0x6000, 0x3000, 0x8, 0x0, 0x1e000, 0x18000, 0x1, 0x7bc180, 0xc1700000, 0x2
    .long 0x40000019, 0x90d800, 0x9cc180, 0xc000, 0x7d4180, 0x1e800, 0x6000, 0x3800, 0x8, 0x0, 0x1e000, 0x1b000, 0x1, 0x7bc180, 0xc1700000, 0x2
L_table2:
    .long 0xffffffff, 0xffffffff, 0xffffffff, 0xffffffff, 0xffffffff, 0xffffffff, 0xffffffff, 0xffffffff
    .long 0xffffffff, 0xffffffff, 0xffffffff, 0xffffffff, 0xffffffff, 0xffffffff, 0xffffffff, 0xffffffff
    .long 0xffffffff, 0xffffffff, 0xffffffff, 0xffffffff, 0xffffffff, 0xffffffff, 0xffffffff, 0xffffffff
    .long 0xffffffff, 0xffffffff, 0xffffffff, 0xffffffff, 0xffffffff, 0xffffffff, 0xffffffff, 0xffffffff
    .long 0xffffffff, 0xffffffff, 0xffffffff, 0xffffffff, 0xffffffff, 0xffffffff, 0xffffffff, 0xffffffff
    .long 0xffffffff, 0xffffffff, 0xffffffff, 0xffffffff, 0xffffffff, 0xffffffff, 0xffffffff, 0xffffffff
    .long 0xffffffff, 0xffffffff, 0xffffffff, 0xffffffff, 0xffffffff, 0xffffffff, 0xffffffff, 0xffffffff
    .long 0xffffffff, 0xffffffff, 0xffffffff, 0xffffffff, 0xffffffff, 0xffffffff, 0xffffffff, 0xffffffff
    .long 0xffffffff, 0xffffffff, 0xffffffff, 0xffffffff, 0xffffffff, 0xffffffff, 0xffffffff, 0xffffffff
    .long 0xffffffff, 0xffffffff, 0xffffffff, 0xffffffff, 0xffffffff, 0xffffffff, 0xffffffff, 0xffffffff
    .long 0xffffffff, 0xffffffff, 0xffffffff, 0xffffffff, 0xffffffff, 0xffffffff, 0xffffffff, 0xffffffff
    .long 0xffffffff, 0xffffffff, 0xffffffff, 0xffffffff, 0xffffffff, 0xffffffff, 0xffffffff, 0xffffffff
    .long 0xffffffff, 0xffffffff, 0xffffffff, 0xffffffff, 0xffffffff, 0xffffffff, 0xffffffff, 0xffffffff
    .long 0xffffffff, 0xffffffff, 0xffffffff, 0xffffffff, 0xffffffff, 0xffffffff, 0xffffffff, 0xffffffff
    .long 0xffffffff, 0xffffffff, 0xffffffff, 0xffffffff, 0xffffffff, 0xffffffff, 0xffffffff, 0xffffffff
    .long 0xffffffff, 0xffffffff, 0xffffffff, 0xffffffff, 0xffffffff, 0xffffffff, 0xffffffff, 0xffffffff
    .long 0xffffffff, 0xffffffff, 0xffffffff, 0xffffffff, 0xffffffff, 0xffffffff, 0xffffffff, 0xffffffff
    .long 0xffffffff, 0xffffffff, 0xffffffff, 0xffffffff, 0xffffffff, 0xffffffff, 0xffffffff, 0xffffffff
    .long 0xffffffff, 0xffffffff, 0xffffffff, 0xffffffff, 0xffffffff, 0xffffffff, 0xffffffff, 0xffffffff
    .long 0xffffffff, 0xffffffff, 0xffffffff, 0xffffffff, 0xffffffff, 0xffffffff, 0xffffffff, 0xffffffff
    .long 0xffffffff, 0xffffffff, 0xffffffff, 0xffffffff, 0xffffffff, 0xffffffff, 0xffffffff, 0xffffffff
    .long 0xffffffff, 0xffffffff, 0xffffffff, 0xffffffff, 0xffffffff, 0xffffffff, 0xffffffff, 0xffffffff
    .long 0xffffffff, 0xffffffff, 0xffffffff, 0xffffffff, 0xffffffff, 0xffffffff, 0xffffffff, 0xffffffff
    .long 0xffffffff, 0xffffffff, 0xffffffff, 0xffffffff, 0xffffffff, 0xffffffff, 0xffffffff, 0xffffffff
    .long 0xffffffff, 0xffffffff, 0xffffffff, 0xffffffff, 0xffffffff, 0xffffffff, 0xffffffff, 0xffffffff
    .long 0xffffffff, 0xffffffff, 0xffffffff, 0xffffffff, 0xffffffff, 0xffffffff, 0xffffffff, 0xffffffff
    .long 0xffffffff, 0xffffffff, 0xffffffff, 0xffffffff, 0xffffffff, 0xffffffff, 0xffffffff, 0xffffffff
    .long 0xffffffff, 0xffffffff, 0xffffffff, 0xffffffff, 0xffffffff, 0xffffffff, 0xffffffff, 0xffffffff
    .long 0xffffffff, 0xffffffff, 0xffffffff, 0xffffffff, 0xffffffff, 0xffffffff, 0xffffffff, 0xffffffff
    .long 0xffffffff, 0xffffffff, 0xffffffff, 0xffffffff, 0xffffffff, 0xffffffff, 0xffffffff, 0xffffffff
    .long 0xffffffff, 0xffffffff, 0xffffffff, 0xffffffff, 0xffffffff, 0xffffffff, 0xffffffff, 0xffffffff
    .long 0xffffffff, 0xffffffff, 0xffffffff, 0xffffffff, 0xffffffff, 0xffffffff, 0xffffffff, 0xffffffff
    .long 0xffffffff, 0xffffffff, 0xffffffff, 0xffffffff, 0xffffffff, 0xffffffff, 0xffffffff, 0xffffffff
    .long 0xffffffff, 0xffffffff, 0xffffffff, 0xffffffff, 0xffffffff, 0xffffffff, 0xffffffff, 0xffffffff
    .long 0xffffffff, 0xffffffff, 0xffffffff, 0xffffffff, 0xffffffff, 0xffffffff, 0xffffffff, 0xffffffff
    .long 0xffffffff, 0xffffffff, 0xffffffff, 0xffffffff, 0xffffffff, 0xffffffff, 0xffffffff, 0xffffffff
    .long 0xffffffff, 0xffffffff, 0xffffffff, 0xffffffff, 0xffffffff, 0xffffffff, 0xffffffff, 0xffffffff
    .long 0xffffffff, 0xffffffff, 0xffffffff, 0xffffffff, 0xffffffff, 0xffffffff, 0xffffffff, 0xffffffff
    .long 0xffffffff, 0xffffffff, 0xffffffff, 0xffffffff, 0xffffffff, 0xffffffff, 0xffffffff, 0xffffffff
    .long 0xffffffff, 0xffffffff, 0xffffffff, 0xffffffff, 0xffffffff, 0xffffffff, 0xffffffff, 0xffffffff
    .long 0xffffffff, 0xffffffff, 0xffffffff, 0xffffffff, 0xffffffff, 0xffffffff, 0xffffffff, 0xffffffff
    .long 0xffffffff, 0xffffffff, 0xffffffff, 0xffffffff, 0xffffffff, 0xffffffff, 0xffffffff, 0xffffffff
    .long 0xffffffff, 0xffffffff, 0xffffffff, 0xffffffff, 0xffffffff, 0xffffffff, 0xffffffff, 0xffffffff
    .long 0xffffffff, 0xffffffff, 0xffffffff, 0xffffffff, 0xffffffff, 0xffffffff, 0xffffffff, 0xffffffff
    .long 0xffffffff, 0xffffffff, 0xffffffff, 0xffffffff, 0xffffffff, 0xffffffff, 0xffffffff, 0xffffffff
    .long 0xffffffff, 0xffffffff, 0xffffffff, 0xffffffff, 0xffffffff, 0xffffffff, 0xffffffff, 0xffffffff
    .long 0xffffffff, 0xffffffff, 0xffffffff, 0xffffffff, 0xffffffff, 0xffffffff, 0xffffffff, 0xffffffff
    .long 0xffffffff, 0xffffffff, 0xffffffff, 0xffffffff, 0xffffffff, 0xffffffff, 0xffffffff, 0xffffffff
    .long 0xffffffff, 0xffffffff, 0xffffffff, 0xffffffff, 0xffffffff, 0xffffffff, 0xffffffff, 0xffffffff
    .long 0xffffffff, 0xffffffff, 0xffffffff, 0xffffffff, 0xffffffff, 0xffffffff, 0xffffffff, 0xffffffff
    .long 0xffffffff, 0xffffffff, 0xffffffff, 0xffffffff, 0xffffffff, 0xffffffff, 0xffffffff, 0xffffffff
    .long 0xffffffff, 0xffffffff, 0xffffffff, 0xffffffff, 0xffffffff, 0xffffffff, 0xffffffff, 0xffffffff
    .long 0xffffffff, 0xffffffff, 0xffffffff, 0xffffffff, 0xffffffff, 0xffffffff, 0xffffffff, 0xffffffff
    .long 0xffffffff, 0xffffffff, 0xffffffff, 0xffffffff, 0xffffffff, 0xffffffff, 0xffffffff, 0xffffffff
    .long 0xffffffff, 0xffffffff, 0xffffffff, 0xffffffff, 0xffffffff, 0xffffffff, 0xffffffff, 0xffffffff
    .long 0xffffffff, 0xffffffff, 0xffffffff, 0xffffffff, 0xffffffff, 0xffffffff, 0xffffffff, 0xffffffff
    .long 0xffffffff, 0xffffffff, 0xffffffff, 0xffffffff, 0xffffffff, 0xffffffff, 0xffffffff, 0xffffffff
    .long 0xffffffff, 0xffffffff, 0xffffffff, 0xffffffff, 0xffffffff, 0xffffffff, 0xffffffff, 0xffffffff
    .long 0xffffffff, 0xffffffff, 0xffffffff, 0xffffffff, 0xffffffff, 0xffffffff, 0xffffffff, 0xffffffff
    .long 0xffffffff, 0xffffffff, 0xffffffff, 0xffffffff, 0xffffffff, 0xffffffff, 0xffffffff, 0xffffffff
    .long 0xffffffff, 0xffffffff, 0xffffffff, 0xffffffff, 0xffffffff, 0xffffffff, 0xffffffff, 0xffffffff
    .long 0xffffffff, 0xffffffff, 0xffffffff, 0xffffffff, 0xffffffff, 0xffffffff, 0xffffffff, 0xffffffff
    .long 0xffffffff, 0xffffffff, 0xffffffff, 0xffffffff, 0xffffffff, 0xffffffff, 0xffffffff, 0xffffffff
    .long 0xffffffff, 0xffffffff, 0xffffffff, 0xffffffff, 0xffffffff, 0xffffffff, 0xffffffff, 0xffffffff
    .long 0xffffffff, 0xffffffff, 0xffffffff, 0xffffffff, 0xffffffff, 0xffffffff, 0xffffffff, 0xffffffff
    .long 0xffffffff, 0xffffffff, 0xffffffff, 0xffffffff, 0xffffffff, 0xffffffff, 0xffffffff, 0xffffffff
    .long 0xffffffff, 0xffffffff, 0xffffffff, 0xffffffff, 0xffffffff, 0xffffffff, 0xffffffff, 0xffffffff
    .long 0xffffffff, 0xffffffff, 0xffffffff, 0xffffffff, 0xffffffff, 0xffffffff, 0xffffffff, 0xffffffff
    .long 0xffffffff, 0xffffffff, 0xffffffff, 0xffffffff, 0xffffffff, 0xffffffff, 0xffffffff, 0xffffffff
    .long 0xffffffff, 0xffffffff, 0xffffffff, 0xffffffff, 0xffffffff, 0xffffffff, 0xffffffff, 0xffffffff
    .long 0xffffffff, 0xffffffff, 0xffffffff, 0xffffffff, 0xffffffff, 0xffffffff, 0xffffffff, 0xffffffff
    .long 0xffffffff, 0xffffffff, 0xffffffff, 0xffffffff, 0xffffffff, 0xffffffff, 0xffffffff, 0xffffffff
    .long 0xffffffff, 0xffffffff, 0xffffffff, 0xffffffff, 0xffffffff, 0xffffffff, 0xffffffff, 0xffffffff
    .long 0xffffffff, 0xffffffff, 0xffffffff, 0xffffffff, 0xffffffff, 0xffffffff, 0xffffffff, 0xffffffff
    .long 0xffffffff, 0xffffffff, 0xffffffff, 0xffffffff, 0xffffffff, 0xffffffff, 0xffffffff, 0xffffffff
    .long 0xffffffff, 0xffffffff, 0xffffffff, 0xffffffff, 0xffffffff, 0xffffffff, 0xffffffff, 0xffffffff
    .long 0xffffffff, 0xffffffff, 0xffffffff, 0xffffffff, 0xffffffff, 0xffffffff, 0xffffffff, 0xffffffff
    .long 0xffffffff, 0xffffffff, 0xffffffff, 0xffffffff, 0xffffffff, 0xffffffff, 0xffffffff, 0xffffffff
    .long 0xffffffff, 0xffffffff, 0xffffffff, 0xffffffff, 0xffffffff, 0xffffffff, 0xffffffff, 0xffffffff
    .long 0xffffffff, 0xffffffff, 0xffffffff, 0xffffffff, 0xffffffff, 0xffffffff, 0xffffffff, 0xffffffff
    .long 0xffffffff, 0xffffffff, 0xffffffff, 0xffffffff, 0xffffffff, 0xffffffff, 0xffffffff, 0xffffffff
    .long 0xffffffff, 0xffffffff, 0xffffffff, 0xffffffff, 0xffffffff, 0xffffffff, 0xffffffff, 0xffffffff
    .long 0xffffffff, 0xffffffff, 0xffffffff, 0xffffffff, 0xffffffff, 0xffffffff, 0xffffffff, 0xffffffff
    .long 0xffffffff, 0xffffffff, 0xffffffff, 0xffffffff, 0xffffffff, 0xffffffff, 0xffffffff, 0xffffffff
    .long 0xffffffff, 0xffffffff, 0xffffffff, 0xffffffff, 0xffffffff, 0xffffffff, 0xffffffff, 0xffffffff
    .long 0xffffffff, 0xffffffff, 0xffffffff, 0xffffffff, 0xffffffff, 0xffffffff, 0xffffffff, 0xffffffff
    .long 0xffffffff, 0xffffffff, 0xffffffff, 0xffffffff, 0xffffffff, 0xffffffff, 0xffffffff, 0xffffffff
    .long 0xffffffff, 0xffffffff, 0xffffffff, 0xffffffff, 0xffffffff, 0xffffffff, 0xffffffff, 0xffffffff
    .long 0xffffffff, 0xffffffff, 0xffffffff, 0xffffffff, 0xffffffff, 0xffffffff, 0xffffffff, 0xffffffff
    .long 0xffffffff, 0xffffffff, 0xffffffff, 0xffffffff, 0xffffffff, 0xffffffff, 0xffffffff, 0xffffffff
    .long 0xffffffff, 0xffffffff, 0xffffffff, 0xffffffff, 0xffffffff, 0xffffffff, 0xffffffff, 0xffffffff
    .long 0xffffffff, 0xffffffff, 0xffffffff, 0xffffffff, 0xffffffff, 0xffffffff, 0xffffffff, 0xffffffff
    .long 0xffffffff, 0xffffffff, 0xffffffff, 0xffffffff, 0xffffffff, 0xffffffff, 0xffffffff, 0xffffffff
    .long 0xffffffff, 0xffffffff, 0xffffffff, 0xffffffff, 0xffffffff, 0xffffffff, 0xffffffff, 0xffffffff
    .long 0xffffffff, 0xffffffff, 0xffffffff, 0xffffffff, 0xffffffff, 0xffffffff, 0xffffffff, 0xffffffff
    .long 0xffffffff, 0xffffffff, 0xffffffff, 0xffffffff, 0xffffffff, 0xffffffff, 0xffffffff, 0xffffffff
    .long 0xffffffff, 0xffffffff, 0xffffffff, 0xffffffff, 0xffffffff, 0xffffffff, 0xffffffff, 0xffffffff
    .long 0xffffffff, 0xffffffff, 0xffffffff, 0xffffffff, 0xffffffff, 0xffffffff, 0xffffffff, 0xffffffff
    .long 0xffffffff, 0xffffffff, 0xffffffff, 0xffffffff, 0xffffffff, 0xffffffff, 0xffffffff, 0xffffffff
    .long 0xffffffff, 0xffffffff, 0xffffffff, 0xffffffff, 0xffffffff, 0xffffffff, 0xffffffff, 0xffffffff
    .long 0xffffffff, 0xffffffff, 0xffffffff, 0xffffffff, 0xffffffff, 0xffffffff, 0xffffffff, 0xffffffff
    .long 0xffffffff, 0xffffffff, 0xffffffff, 0xffffffff, 0xffffffff, 0xffffffff, 0xffffffff, 0xffffffff
    .long 0xffffffff, 0xffffffff, 0xffffffff, 0xffffffff, 0xffffffff, 0xffffffff, 0xffffffff, 0xffffffff
    .long 0xffffffff, 0xffffffff, 0xffffffff, 0xffffffff, 0xffffffff, 0xffffffff, 0xffffffff, 0xffffffff
    .long 0xffffffff, 0xffffffff, 0xffffffff, 0xffffffff, 0xffffffff, 0xffffffff, 0xffffffff, 0xffffffff
    .long 0xffffffff, 0xffffffff, 0xffffffff, 0xffffffff, 0xffffffff, 0xffffffff, 0xffffffff, 0xffffffff
    .long 0xffffffff, 0xffffffff, 0xffffffff, 0xffffffff, 0xffffffff, 0xffffffff, 0xffffffff, 0xffffffff
    .long 0xffffffff, 0xffffffff, 0xffffffff, 0xffffffff, 0xffffffff, 0xffffffff, 0xffffffff, 0xffffffff
    .long 0xffffffff, 0xffffffff, 0xffffffff, 0xffffffff, 0xffffffff, 0xffffffff, 0xffffffff, 0xffffffff
    .long 0xffffffff, 0xffffffff, 0xffffffff, 0xffffffff, 0xffffffff, 0xffffffff, 0xffffffff, 0xffffffff
    .long 0xffffffff, 0xffffffff, 0xffffffff, 0xffffffff, 0xffffffff, 0xffffffff, 0xffffffff, 0xffffffff
    .long 0xffffffff, 0xffffffff, 0xffffffff, 0xffffffff, 0xffffffff, 0xffffffff, 0xffffffff, 0xffffffff
    .long 0xffffffff, 0xffffffff, 0xffffffff, 0xffffffff, 0xffffffff, 0xffffffff, 0xffffffff, 0xffffffff
    .long 0xffffffff, 0xffffffff, 0xffffffff, 0xffffffff, 0xffffffff, 0xffffffff, 0xffffffff, 0xffffffff
    .long 0xffffffff, 0xffffffff, 0xffffffff, 0xffffffff, 0xffffffff, 0xffffffff, 0xffffffff, 0xffffffff
    .long 0xffffffff, 0xffffffff, 0xffffffff, 0xffffffff, 0xffffffff, 0xffffffff, 0xffffffff, 0xffffffff
    .long 0xffffffff, 0xffffffff, 0xffffffff, 0xffffffff, 0xffffffff, 0xffffffff, 0xffffffff, 0xffffffff
    .long 0xffffffff, 0xffffffff, 0xffffffff, 0xffffffff, 0xffffffff, 0xffffffff, 0xffffffff, 0xffffffff
    .long 0xffffffff, 0xffffffff, 0xffffffff, 0xffffffff, 0xffffffff, 0xffffffff, 0xffffffff, 0xffffffff
    .long 0xffffffff, 0xffffffff, 0xffffffff, 0xffffffff, 0xffffffff, 0xffffffff, 0xffffffff, 0xffffffff
    .long 0xffffffff, 0xffffffff, 0xffffffff, 0xffffffff, 0xffffffff, 0xffffffff, 0xffffffff, 0xffffffff
    .long 0xffffffff, 0xffffffff, 0xffffffff, 0xffffffff, 0xffffffff, 0xffffffff, 0xffffffff, 0xffffffff
    .long 0xffffffff, 0xffffffff, 0xffffffff, 0xffffffff, 0xffffffff, 0xffffffff, 0xffffffff, 0xffffffff
    .long 0xffffffff, 0xffffffff, 0xffffffff, 0xffffffff, 0xffffffff, 0xffffffff, 0xffffffff, 0xffffffff
    .long 0xffffffff, 0xffffffff, 0xffffffff, 0xffffffff, 0xffffffff, 0xffffffff, 0xffffffff, 0xffffffff
    .long 0xffffffff, 0xffffffff, 0xffffffff, 0xffffffff, 0xffffffff, 0xffffffff, 0xffffffff, 0xffffffff
    .long 0xffffffff, 0xffffffff, 0xffffffff, 0xffffffff, 0xffffffff, 0xffffffff, 0xffffffff, 0xffffffff
    .long 0xffffffff, 0xffffffff, 0xffffffff, 0xffffffff, 0xffffffff, 0xffffffff, 0xffffffff, 0xffffffff
    .long 0xffffffff, 0xffffffff, 0xffffffff, 0xffffffff, 0xffffffff, 0xffffffff, 0xffffffff, 0xffffffff
    .long 0xffffffff, 0xffffffff, 0xffffffff, 0xffffffff, 0xffffffff, 0xffffffff, 0xffffffff, 0xffffffff
    .long 0xffffffff, 0xffffffff, 0xffffffff, 0xffffffff, 0xffffffff, 0xffffffff, 0xffffffff, 0xffffffff
    .long 0xffffffff, 0xffffffff, 0xffffffff, 0xffffffff, 0xffffffff, 0xffffffff, 0xffffffff, 0xffffffff
    .long 0xffffffff, 0xffffffff, 0xffffffff, 0xffffffff, 0xffffffff, 0xffffffff, 0xffffffff, 0xffffffff
    .long 0xffffffff, 0xffffffff, 0xffffffff, 0xffffffff, 0xffffffff, 0xffffffff, 0xffffffff, 0xffffffff
    .long 0xffffffff, 0xffffffff, 0xffffffff, 0xffffffff, 0xffffffff, 0xffffffff, 0xffffffff, 0xffffffff
    .long 0xffffffff, 0xffffffff, 0xffffffff, 0xffffffff, 0xffffffff, 0xffffffff, 0xffffffff, 0xffffffff
    .long 0xffffffff, 0xffffffff, 0xffffffff, 0xffffffff, 0xffffffff, 0xffffffff, 0xffffffff, 0xffffffff
    .long 0xffffffff, 0xffffffff, 0xffffffff, 0xffffffff, 0xffffffff, 0xffffffff, 0xffffffff, 0xffffffff
    .long 0xffffffff, 0xffffffff, 0xffffffff, 0xffffffff, 0xffffffff, 0xffffffff, 0xffffffff, 0xffffffff
    .long 0xffffffff, 0xffffffff, 0xffffffff, 0xffffffff, 0xffffffff, 0xffffffff, 0xffffffff, 0xffffffff
    .long 0xffffffff, 0xffffffff, 0xffffffff, 0xffffffff, 0xffffffff, 0xffffffff, 0xffffffff, 0xffffffff
    .long 0xffffffff, 0xffffffff, 0xffffffff, 0xffffffff, 0xffffffff, 0xffffffff, 0xffffffff, 0xffffffff
    .long 0xffffffff, 0xffffffff, 0xffffffff, 0xffffffff, 0xffffffff, 0xffffffff, 0xffffffff, 0xffffffff
    .long 0xffffffff, 0xffffffff, 0xffffffff, 0xffffffff, 0xffffffff, 0xffffffff, 0xffffffff, 0xffffffff
    .long 0xffffffff, 0xffffffff, 0xffffffff, 0xffffffff, 0xffffffff, 0xffffffff, 0xffffffff, 0xffffffff
    .long 0xffffffff, 0xffffffff, 0xffffffff, 0xffffffff, 0xffffffff, 0xffffffff, 0xffffffff, 0xffffffff
    .long 0xffffffff, 0xffffffff, 0xffffffff, 0xffffffff, 0xffffffff, 0xffffffff, 0xffffffff, 0xffffffff
    .long 0xffffffff, 0xffffffff, 0xffffffff, 0xffffffff, 0xffffffff, 0xffffffff, 0xffffffff, 0xffffffff
    .long 0xffffffff, 0xffffffff, 0xffffffff, 0xffffffff, 0xffffffff, 0xffffffff, 0xffffffff, 0xffffffff
    .long 0xffffffff, 0xffffffff, 0xffffffff, 0xffffffff, 0xffffffff, 0xffffffff, 0xffffffff, 0xffffffff
    .long 0xffffffff, 0xffffffff, 0xffffffff, 0xffffffff, 0xffffffff, 0xffffffff, 0xffffffff, 0xffffffff
    .long 0xffffffff, 0xffffffff, 0xffffffff, 0xffffffff, 0xffffffff, 0xffffffff, 0xffffffff, 0xffffffff
    .long 0x544800, 0xffffffff, 0xffffffff, 0xffffffff, 0xffffffff, 0xffffffff, 0xffffffff, 0xffffffff
    .long 0x80550800, 0xffffffff, 0xffffffff, 0xffffffff, 0xffffffff, 0xffffffff, 0xffffffff, 0xffffffff
    .long 0x5ec800, 0xffffffff, 0xffffffff, 0xffffffff, 0xffffffff, 0xffffffff, 0xffffffff, 0xffffffff
    .long 0x805f8800, 0xffffffff, 0xffffffff, 0xffffffff, 0xffffffff, 0xffffffff, 0xffffffff, 0xffffffff
    .long 0x80634800, 0xffffffff, 0xffffffff, 0xffffffff, 0xffffffff, 0xffffffff, 0xffffffff, 0xffffffff
    .long 0xffffffff, 0xffffffff, 0xffffffff, 0xffffffff, 0xffffffff, 0xffffffff, 0xffffffff, 0xffffffff
    .long 0xffffffff, 0xffffffff, 0xffffffff, 0xffffffff, 0xffffffff, 0xffffffff, 0xffffffff, 0xffffffff
    .long 0xffffffff, 0xffffffff, 0xffffffff, 0xffffffff, 0xffffffff, 0xffffffff, 0xffffffff, 0xffffffff
    .long 0x550800, 0xffffffff, 0xffffffff, 0xffffffff, 0xffffffff, 0xffffffff, 0xffffffff, 0xffffffff
    .long 0x8055c800, 0xffffffff, 0xffffffff, 0xffffffff, 0xffffffff, 0xffffffff, 0xffffffff, 0xffffffff
    .long 0x5f8800, 0xffffffff, 0xffffffff, 0xffffffff, 0xffffffff, 0xffffffff, 0xffffffff, 0xffffffff
    .long 0x634800, 0xffffffff, 0xffffffff, 0xffffffff, 0xffffffff, 0xffffffff, 0xffffffff, 0xffffffff
    .long 0x80640800, 0xffffffff, 0xffffffff, 0xffffffff, 0xffffffff, 0xffffffff, 0xffffffff, 0xffffffff
    .long 0xffffffff, 0xffffffff, 0xffffffff, 0xffffffff, 0xffffffff, 0xffffffff, 0xffffffff, 0xffffffff
    .long 0xffffffff, 0xffffffff, 0xffffffff, 0xffffffff, 0xffffffff, 0xffffffff, 0xffffffff, 0xffffffff
    .long 0xffffffff, 0xffffffff, 0xffffffff, 0xffffffff, 0xffffffff, 0xffffffff, 0xffffffff, 0xffffffff
    .long 0x55c800, 0xffffffff, 0xffffffff, 0xffffffff, 0xffffffff, 0xffffffff, 0xffffffff, 0xffffffff
    .long 0x80568800, 0xffffffff, 0xffffffff, 0xffffffff, 0xffffffff, 0xffffffff, 0xffffffff, 0xffffffff
    .long 0x805a4800, 0xffffffff, 0xffffffff, 0xffffffff, 0xffffffff, 0xffffffff, 0xffffffff, 0xffffffff
    .long 0x640800, 0xffffffff, 0xffffffff, 0xffffffff, 0xffffffff, 0xffffffff, 0xffffffff, 0xffffffff
    .long 0x8064c800, 0xffffffff, 0xffffffff, 0xffffffff, 0xffffffff, 0xffffffff, 0xffffffff, 0xffffffff
    .long 0xffffffff, 0xffffffff, 0xffffffff, 0xffffffff, 0xffffffff, 0xffffffff, 0xffffffff, 0xffffffff
    .long 0xffffffff, 0xffffffff, 0xffffffff, 0xffffffff, 0xffffffff, 0xffffffff, 0xffffffff, 0xffffffff
    .long 0xffffffff, 0xffffffff, 0xffffffff, 0xffffffff, 0xffffffff, 0xffffffff, 0xffffffff, 0xffffffff
    .long 0x568800, 0xffffffff, 0xffffffff, 0xffffffff, 0xffffffff, 0xffffffff, 0xffffffff, 0xffffffff
    .long 0x5a4800, 0xffffffff, 0xffffffff, 0xffffffff, 0xffffffff, 0xffffffff, 0xffffffff, 0xffffffff
    .long 0x805b0800, 0xffffffff, 0xffffffff, 0xffffffff, 0xffffffff, 0xffffffff, 0xffffffff, 0xffffffff
    .long 0x64c800, 0xffffffff, 0xffffffff, 0xffffffff, 0xffffffff, 0xffffffff, 0xffffffff, 0xffffffff
    .long 0x80658800, 0xffffffff, 0xffffffff, 0xffffffff, 0xffffffff, 0xffffffff, 0xffffffff, 0xffffffff
    .long 0xffffffff, 0xffffffff, 0xffffffff, 0xffffffff, 0xffffffff, 0xffffffff, 0xffffffff, 0xffffffff
    .long 0xffffffff, 0xffffffff, 0xffffffff, 0xffffffff, 0xffffffff, 0xffffffff, 0xffffffff, 0xffffffff
    .long 0xffffffff, 0xffffffff, 0xffffffff, 0xffffffff, 0xffffffff, 0xffffffff, 0xffffffff, 0xffffffff
    .long 0x80514800, 0xffffffff, 0xffffffff, 0xffffffff, 0xffffffff, 0xffffffff, 0xffffffff, 0xffffffff
    .long 0x5b0800, 0xffffffff, 0xffffffff, 0xffffffff, 0xffffffff, 0xffffffff, 0xffffffff, 0xffffffff
    .long 0x805bc800, 0xffffffff, 0xffffffff, 0xffffffff, 0xffffffff, 0xffffffff, 0xffffffff, 0xffffffff
    .long 0x658800, 0xffffffff, 0xffffffff, 0xffffffff, 0xffffffff, 0xffffffff, 0xffffffff, 0xffffffff
    .long 0x694800, 0xffffffff, 0xffffffff, 0xffffffff, 0xffffffff, 0xffffffff, 0xffffffff, 0xffffffff
    .long 0xffffffff, 0xffffffff, 0xffffffff, 0xffffffff, 0xffffffff, 0xffffffff, 0xffffffff, 0xffffffff
    .long 0xffffffff, 0xffffffff, 0xffffffff, 0xffffffff, 0xffffffff, 0xffffffff, 0xffffffff, 0xffffffff
    .long 0xffffffff, 0xffffffff, 0xffffffff, 0xffffffff, 0xffffffff, 0xffffffff, 0xffffffff, 0xffffffff
    .long 0x80520800, 0x6d0800, 0xffffffff, 0xffffffff, 0xffffffff, 0xffffffff, 0xffffffff, 0xffffffff
    .long 0x5bc800, 0x700800, 0xffffffff, 0xffffffff, 0xffffffff, 0xffffffff, 0xffffffff, 0xffffffff
    .long 0x805c8800, 0x730800, 0xffffffff, 0xffffffff, 0xffffffff, 0xffffffff, 0xffffffff, 0xffffffff
    .long 0x80604800, 0x760800, 0xffffffff, 0xffffffff, 0xffffffff, 0xffffffff, 0xffffffff, 0xffffffff
    .long 0x6a0800, 0x790800, 0xffffffff, 0xffffffff, 0xffffffff, 0xffffffff, 0xffffffff, 0xffffffff
    .long 0xffffffff, 0xffffffff, 0xffffffff, 0xffffffff, 0xffffffff, 0xffffffff, 0xffffffff, 0xffffffff
    .long 0xffffffff, 0xffffffff, 0xffffffff, 0xffffffff, 0xffffffff, 0xffffffff, 0xffffffff, 0xffffffff
    .long 0xffffffff, 0xffffffff, 0xffffffff, 0xffffffff, 0xffffffff, 0xffffffff, 0xffffffff, 0xffffffff
    .long 0x8052c800, 0x6dc800, 0xffffffff, 0xffffffff, 0xffffffff, 0xffffffff, 0xffffffff, 0xffffffff
    .long 0x5c8800, 0x70c800, 0xffffffff, 0xffffffff, 0xffffffff, 0xffffffff, 0xffffffff, 0xffffffff
    .long 0x604800, 0x73c800, 0xffffffff, 0xffffffff, 0xffffffff, 0xffffffff, 0xffffffff, 0xffffffff
    .long 0x80610800, 0x76c800, 0xffffffff, 0xffffffff, 0xffffffff, 0xffffffff, 0xffffffff, 0xffffffff
    .long 0x6ac800, 0x79c800, 0xffffffff, 0xffffffff, 0xffffffff, 0xffffffff, 0xffffffff, 0xffffffff
    .long 0xffffffff, 0xffffffff, 0xffffffff, 0xffffffff, 0xffffffff, 0xffffffff, 0xffffffff, 0xffffffff
    .long 0xffffffff, 0xffffffff, 0xffffffff, 0xffffffff, 0xffffffff, 0xffffffff, 0xffffffff, 0xffffffff
    .long 0xffffffff, 0xffffffff, 0xffffffff, 0xffffffff, 0xffffffff, 0xffffffff, 0xffffffff, 0xffffffff
    .long 0x80538800, 0x6e8800, 0xffffffff, 0xffffffff, 0xffffffff, 0xffffffff, 0xffffffff, 0xffffffff
    .long 0x80574800, 0x718800, 0xffffffff, 0xffffffff, 0xffffffff, 0xffffffff, 0xffffffff, 0xffffffff
    .long 0x610800, 0x748800, 0xffffffff, 0xffffffff, 0xffffffff, 0xffffffff, 0xffffffff, 0xffffffff
    .long 0x8061c800, 0x778800, 0xffffffff, 0xffffffff, 0xffffffff, 0xffffffff, 0xffffffff, 0xffffffff
    .long 0x6b8800, 0x7a8800, 0xffffffff, 0xffffffff, 0xffffffff, 0xffffffff, 0xffffffff, 0xffffffff
    .long 0xffffffff, 0xffffffff, 0xffffffff, 0xffffffff, 0xffffffff, 0xffffffff, 0xffffffff, 0xffffffff
    .long 0xffffffff, 0xffffffff, 0xffffffff, 0xffffffff, 0xffffffff, 0xffffffff, 0xffffffff, 0xffffffff
    .long 0xffffffff, 0xffffffff, 0xffffffff, 0xffffffff, 0xffffffff, 0xffffffff, 0xffffffff, 0xffffffff
    .long 0x574800, 0x80694800, 0xffffffff, 0xffffffff, 0xffffffff, 0xffffffff, 0xffffffff, 0xffffffff
    .long 0x80580800, 0x806c4800, 0xffffffff, 0xffffffff, 0xffffffff, 0xffffffff, 0xffffffff, 0xffffffff
    .long 0x61c800, 0x806f4800, 0xffffffff, 0xffffffff, 0xffffffff, 0xffffffff, 0xffffffff, 0xffffffff
    .long 0x80628800, 0x80724800, 0xffffffff, 0xffffffff, 0xffffffff, 0xffffffff, 0xffffffff, 0xffffffff
    .long 0x80664800, 0x80754800, 0xffffffff, 0xffffffff, 0xffffffff, 0xffffffff, 0xffffffff, 0xffffffff
    .long 0xffffffff, 0xffffffff, 0xffffffff, 0xffffffff, 0xffffffff, 0xffffffff, 0xffffffff, 0xffffffff
    .long 0xffffffff, 0xffffffff, 0xffffffff, 0xffffffff, 0xffffffff, 0xffffffff, 0xffffffff, 0xffffffff
    .long 0xffffffff, 0xffffffff, 0xffffffff, 0xffffffff, 0xffffffff, 0xffffffff, 0xffffffff, 0xffffffff
    .long 0x580800, 0x806a0800, 0x80784800, 0xffffffff, 0xffffffff, 0xffffffff, 0xffffffff, 0xffffffff
    .long 0x8058c800, 0x806d0800, 0x807b4800, 0xffffffff, 0xffffffff, 0xffffffff, 0xffffffff, 0xffffffff
    .long 0x628800, 0x80700800, 0x258000, 0xffffffff, 0xffffffff, 0xffffffff, 0xffffffff, 0xffffffff
    .long 0x664800, 0x80730800, 0x288000, 0xffffffff, 0xffffffff, 0xffffffff, 0xffffffff, 0xffffffff
    .long 0x80670800, 0x80760800, 0x80258000, 0xffffffff, 0xffffffff, 0xffffffff, 0xffffffff, 0xffffffff
    .long 0xffffffff, 0xffffffff, 0xffffffff, 0xffffffff, 0xffffffff, 0xffffffff, 0xffffffff, 0xffffffff
    .long 0xffffffff, 0xffffffff, 0xffffffff, 0xffffffff, 0xffffffff, 0xffffffff, 0xffffffff, 0xffffffff
    .long 0xffffffff, 0xffffffff, 0xffffffff, 0xffffffff, 0xffffffff, 0xffffffff, 0xffffffff, 0xffffffff
    .long 0x58c800, 0x806ac800, 0x80790800, 0xffffffff, 0xffffffff, 0xffffffff, 0xffffffff, 0xffffffff
    .long 0x80598800, 0x806dc800, 0x234000, 0xffffffff, 0xffffffff, 0xffffffff, 0xffffffff, 0xffffffff
    .long 0x805d4800, 0x8070c800, 0x264000, 0xffffffff, 0xffffffff, 0xffffffff, 0xffffffff, 0xffffffff
    .long 0x670800, 0x8073c800, 0x80234000, 0xffffffff, 0xffffffff, 0xffffffff, 0xffffffff, 0xffffffff
    .long 0x8067c800, 0x8076c800, 0x294000, 0xffffffff, 0xffffffff, 0xffffffff, 0xffffffff, 0xffffffff
    .long 0xffffffff, 0xffffffff, 0xffffffff, 0xffffffff, 0xffffffff, 0xffffffff, 0xffffffff, 0xffffffff
    .long 0xffffffff, 0xffffffff, 0xffffffff, 0xffffffff, 0xffffffff, 0xffffffff, 0xffffffff, 0xffffffff
    .long 0xffffffff, 0xffffffff, 0xffffffff, 0xffffffff, 0xffffffff, 0xffffffff, 0xffffffff, 0xffffffff
    .long 0x598800, 0x806b8800, 0x8079c800, 0xffffffff, 0xffffffff, 0xffffffff, 0xffffffff, 0xffffffff
    .long 0x5d4800, 0x806e8800, 0x240000, 0xffffffff, 0xffffffff, 0xffffffff, 0xffffffff, 0xffffffff
    .long 0x805e0800, 0x80718800, 0x270000, 0xffffffff, 0xffffffff, 0xffffffff, 0xffffffff, 0xffffffff
    .long 0x67c800, 0x80748800, 0x80240000, 0xffffffff, 0xffffffff, 0xffffffff, 0xffffffff, 0xffffffff
    .long 0x80688800, 0x80778800, 0x2a0000, 0xffffffff, 0xffffffff, 0xffffffff, 0xffffffff, 0xffffffff
    .long 0xffffffff, 0xffffffff, 0xffffffff, 0xffffffff, 0xffffffff, 0xffffffff, 0xffffffff, 0xffffffff
    .long 0xffffffff, 0xffffffff, 0xffffffff, 0xffffffff, 0xffffffff, 0xffffffff, 0xffffffff, 0xffffffff
    .long 0xffffffff, 0xffffffff, 0xffffffff, 0xffffffff, 0xffffffff, 0xffffffff, 0xffffffff, 0xffffffff
    .long 0x80544800, 0x6f4800, 0x807a8800, 0xffffffff, 0xffffffff, 0xffffffff, 0xffffffff, 0xffffffff
    .long 0x5e0800, 0x724800, 0x24c000, 0xffffffff, 0xffffffff, 0xffffffff, 0xffffffff, 0xffffffff
    .long 0x805ec800, 0x754800, 0x27c000, 0xffffffff, 0xffffffff, 0xffffffff, 0xffffffff, 0xffffffff
    .long 0x688800, 0x784800, 0x8024c000, 0xffffffff, 0xffffffff, 0xffffffff, 0xffffffff, 0xffffffff
    .long 0x6c4800, 0x7b4800, 0x2ac000, 0xffffffff, 0xffffffff, 0xffffffff, 0xffffffff, 0xffffffff
    .long 0xffffffff, 0xffffffff, 0xffffffff, 0xffffffff, 0xffffffff, 0xffffffff, 0xffffffff, 0xffffffff
    .long 0xffffffff, 0xffffffff, 0xffffffff, 0xffffffff, 0xffffffff, 0xffffffff, 0xffffffff, 0xffffffff
    .long 0xffffffff, 0xffffffff, 0xffffffff, 0xffffffff, 0xffffffff, 0xffffffff, 0xffffffff, 0xffffffff
.size L_table, 24576
.section .rodata,"a"
.p2align 6
.amdhsa_kernel standalone__varlen_attn_packed__ragged_kernel
  .amdhsa_next_free_vgpr 256
  .amdhsa_next_free_sgpr 96
  .amdhsa_accum_offset 256
  .amdhsa_group_segment_fixed_size 0
  .amdhsa_kernarg_size 56
  .amdhsa_user_sgpr_count 2
  .amdhsa_user_sgpr_kernarg_segment_ptr 1
  .amdhsa_system_sgpr_workgroup_id_x 1
.end_amdhsa_kernel
```
